```python
import torch

def _softmax(x, axis=-1):
    return torch.softmax(x, dim=axis)
def _gelu(x):
    return torch.nn.functional.gelu(x, approximate="tanh")
def _silu(x):
    return torch.nn.functional.silu(x)
def _sigmoid(x):
    return torch.sigmoid(x)
def _layernorm(x, axis=-1, eps=1e-5):
    m = x.mean(dim=axis, keepdim=True)
    v = x.var(dim=axis, keepdim=True, unbiased=False)
    return (x - m) / torch.sqrt(v + eps)
def _scatter_add(tgt, idx, src, axis=0):
    return tgt.clone().index_add_(axis, idx, src)
def _segment_sum(src, seg, n):
    out = torch.zeros((n,) + src.shape[1:], dtype=src.dtype)
    return out.index_add_(0, seg, src)
def _pad(x, pw):
    flat = tuple(v for pair in reversed(pw) for v in pair)
    return torch.nn.functional.pad(x, flat)

kernel_name = 'standalone__edge_featured_mpnn_gatedgcn__graph'

def setup_inputs():

    _w = (lambda a: (lambda t: t.to(torch.bfloat16) if t.is_floating_point() else t)(torch.as_tensor(a)))
    N, deg, D, De = 25000, 32, 64, max(16, 1)
    E = N * deg
    return {
        "x": _w((lambda *s: torch.randn(*s, dtype=torch.bfloat16) * 0.8)(N, D)),
        "e_attr": _w((lambda *s: torch.randn(*s, dtype=torch.bfloat16) * 0.8)(E, De)),
        "src": _w((lambda lo, hi, *s: torch.randint(lo, hi, s))(0, N, E).to(torch.int64)),
        "dst": _w((lambda lo, hi, *s: torch.randint(lo, hi, s))(0, N, E).to(torch.int64)),
        "w_a": _w((lambda *s: torch.randn(*s, dtype=torch.bfloat16) * 0.8)(D, D)),
        "w_b": _w((lambda *s: torch.randn(*s, dtype=torch.bfloat16) * 0.8)(D, D)),
        "w_c": _w((lambda *s: torch.randn(*s, dtype=torch.bfloat16) * 0.8)(De, D)),
        "w_u": _w((lambda *s: torch.randn(*s, dtype=torch.bfloat16) * 0.05)(D, D)),
        "w_v": _w((lambda *s: torch.randn(*s, dtype=torch.bfloat16) * 0.05)(D, D)),
    }

def reference(x, e_attr, src, dst, w_a, w_b, w_c, w_u, w_v):
    N, D = x.shape
    hv = x @ w_v
    g = x[dst] @ w_a + x[src] @ w_b + e_attr @ w_c
    eta = _sigmoid(g)
    denom = _segment_sum(eta, dst, N) + 1e-6
    eta_n = eta / denom[dst]
    agg = _segment_sum(eta_n * hv[src], dst, N)
    z = x @ w_u + agg
    relu_z = torch.where(z > 0, z, 0 * z)
    return x + relu_z
```

```asm
; @launch kernel=part_kernel grid=(257,1,1) block=(256,1,1) lds=2048
; @launch kernel=main_kernel grid=(512,1,1) block=(256,1,1) lds=74208
.amdgcn_target "amdgcn-amd-amdhsa--gfx950"
.text
.globl part_kernel
.p2align 8
.type part_kernel,@function
part_kernel:
s_cmp_gt_u32 s2, 256
s_cbranch_scc1 P_END
s_cmp_eq_u32 s2, 256
s_cbranch_scc1 P_FRAG
s_load_dwordx4 s[4:7], s[0:1], 16
s_load_dwordx2 s[8:9], s[0:1], 88
s_waitcnt lgkmcnt(0)
s_mov_b32 s12, s4
s_mov_b32 s13, s5
s_mov_b32 s14, 3200000
s_mov_b32 s15, 0x00020000
s_mov_b32 s16, s6
s_mov_b32 s17, s7
s_mov_b32 s18, 3200000
s_mov_b32 s19, 0x00020000
s_mov_b32 s20, s8
s_mov_b32 s21, s9
s_mov_b32 s22, 268435456
s_mov_b32 s23, 0x00020000
v_lshlrev_b32 v1, 2, v0
v_mov_b32 v2, 0
ds_write_b32 v1, v2
ds_write_b32 v1, v2 offset:1024
s_waitcnt lgkmcnt(0)
s_barrier
s_mul_i32 s24, s2, 3125
s_lshl_b32 s25, s24, 2
v_add_u32 v3, 0, v1
buffer_load_dword v10, v3, s[16:19], s25 offen
buffer_load_dword v30, v3, s[12:15], s25 offen
v_add_u32 v3, 1024, v1
buffer_load_dword v11, v3, s[16:19], s25 offen
buffer_load_dword v31, v3, s[12:15], s25 offen
v_add_u32 v3, 2048, v1
buffer_load_dword v12, v3, s[16:19], s25 offen
buffer_load_dword v32, v3, s[12:15], s25 offen
v_add_u32 v3, 3072, v1
buffer_load_dword v13, v3, s[16:19], s25 offen
buffer_load_dword v33, v3, s[12:15], s25 offen
v_add_u32 v3, 4096, v1
buffer_load_dword v14, v3, s[16:19], s25 offen
buffer_load_dword v34, v3, s[12:15], s25 offen
v_add_u32 v3, 5120, v1
buffer_load_dword v15, v3, s[16:19], s25 offen
buffer_load_dword v35, v3, s[12:15], s25 offen
v_add_u32 v3, 6144, v1
buffer_load_dword v16, v3, s[16:19], s25 offen
buffer_load_dword v36, v3, s[12:15], s25 offen
v_add_u32 v3, 7168, v1
buffer_load_dword v17, v3, s[16:19], s25 offen
buffer_load_dword v37, v3, s[12:15], s25 offen
v_add_u32 v3, 8192, v1
buffer_load_dword v18, v3, s[16:19], s25 offen
buffer_load_dword v38, v3, s[12:15], s25 offen
v_add_u32 v3, 9216, v1
buffer_load_dword v19, v3, s[16:19], s25 offen
buffer_load_dword v39, v3, s[12:15], s25 offen
v_add_u32 v3, 10240, v1
buffer_load_dword v20, v3, s[16:19], s25 offen
buffer_load_dword v40, v3, s[12:15], s25 offen
v_add_u32 v3, 11264, v1
buffer_load_dword v21, v3, s[16:19], s25 offen
buffer_load_dword v41, v3, s[12:15], s25 offen
v_cmp_gt_u32 vcc, 53, v0
s_and_saveexec_b64 s[26:27], vcc
v_add_u32 v3, 12288, v1
buffer_load_dword v22, v3, s[16:19], s25 offen
buffer_load_dword v42, v3, s[12:15], s25 offen
s_mov_b64 exec, s[26:27]
v_mov_b32 v4, 1
s_waitcnt vmcnt(0)
v_and_b32 v5, 511, v10
v_lshlrev_b32 v70, 2, v5
ds_add_rtn_u32 v50, v70, v4
v_and_b32 v5, 511, v11
v_lshlrev_b32 v71, 2, v5
ds_add_rtn_u32 v51, v71, v4
v_and_b32 v5, 511, v12
v_lshlrev_b32 v72, 2, v5
ds_add_rtn_u32 v52, v72, v4
v_and_b32 v5, 511, v13
v_lshlrev_b32 v73, 2, v5
ds_add_rtn_u32 v53, v73, v4
v_and_b32 v5, 511, v14
v_lshlrev_b32 v74, 2, v5
ds_add_rtn_u32 v54, v74, v4
v_and_b32 v5, 511, v15
v_lshlrev_b32 v75, 2, v5
ds_add_rtn_u32 v55, v75, v4
v_and_b32 v5, 511, v16
v_lshlrev_b32 v76, 2, v5
ds_add_rtn_u32 v56, v76, v4
v_and_b32 v5, 511, v17
v_lshlrev_b32 v77, 2, v5
ds_add_rtn_u32 v57, v77, v4
v_and_b32 v5, 511, v18
v_lshlrev_b32 v78, 2, v5
ds_add_rtn_u32 v58, v78, v4
v_and_b32 v5, 511, v19
v_lshlrev_b32 v79, 2, v5
ds_add_rtn_u32 v59, v79, v4
v_and_b32 v5, 511, v20
v_lshlrev_b32 v80, 2, v5
ds_add_rtn_u32 v60, v80, v4
v_and_b32 v5, 511, v21
v_lshlrev_b32 v81, 2, v5
ds_add_rtn_u32 v61, v81, v4
s_and_saveexec_b64 s[26:27], vcc
v_and_b32 v5, 511, v22
v_lshlrev_b32 v82, 2, v5
ds_add_rtn_u32 v62, v82, v4
s_mov_b64 exec, s[26:27]
s_waitcnt lgkmcnt(0)
s_barrier
v_cmp_gt_u32 vcc, 64, v0
s_and_saveexec_b64 s[28:29], vcc
s_cbranch_execz P_S2
v_lshlrev_b32 v5, 5, v0
ds_read_b128 v[96:99], v5
ds_read_b128 v[100:103], v5 offset:16
s_waitcnt lgkmcnt(0)
v_mov_b32 v6, 0
v_mov_b32 v104, v6
v_add_u32 v6, v6, v96
v_mov_b32 v105, v6
v_add_u32 v6, v6, v97
v_mov_b32 v106, v6
v_add_u32 v6, v6, v98
v_mov_b32 v107, v6
v_add_u32 v6, v6, v99
v_mov_b32 v108, v6
v_add_u32 v6, v6, v100
v_mov_b32 v109, v6
v_add_u32 v6, v6, v101
v_mov_b32 v110, v6
v_add_u32 v6, v6, v102
v_mov_b32 v111, v6
v_add_u32 v6, v6, v103
v_mov_b32 v7, v6
s_nop 1
v_add_u32_dpp v6, v6, v6 row_shr:1 row_mask:0xf bank_mask:0xf bound_ctrl:0
s_nop 1
v_add_u32_dpp v6, v6, v6 row_shr:2 row_mask:0xf bank_mask:0xf bound_ctrl:0
s_nop 1
v_add_u32_dpp v6, v6, v6 row_shr:4 row_mask:0xf bank_mask:0xf bound_ctrl:0
s_nop 1
v_add_u32_dpp v6, v6, v6 row_shr:8 row_mask:0xf bank_mask:0xf bound_ctrl:0
s_nop 1
v_add_u32_dpp v6, v6, v6 row_bcast:15 row_mask:0xa bank_mask:0xf
s_nop 1
v_add_u32_dpp v6, v6, v6 row_bcast:31 row_mask:0xc bank_mask:0xf
s_nop 1
v_sub_u32 v6, v6, v7
v_add_u32 v104, v104, v6
v_add_u32 v105, v105, v6
v_add_u32 v106, v106, v6
v_add_u32 v107, v107, v6
v_add_u32 v108, v108, v6
v_add_u32 v109, v109, v6
v_add_u32 v110, v110, v6
v_add_u32 v111, v111, v6
ds_write_b128 v5, v[104:107]
ds_write_b128 v5, v[108:111] offset:16
s_mul_i32 s30, s2, 2080
s_add_u32 s30, s30, 8388608
buffer_store_dwordx4 v[104:107], v5, s[20:23], s30 offen
buffer_store_dwordx4 v[108:111], v5, s[20:23], s30 offen offset:16
v_mov_b32 v8, 3125
v_mov_b32 v9, 2048
buffer_store_dword v8, v9, s[20:23], s30 offen
s_waitcnt lgkmcnt(0)
P_S2:
s_mov_b64 exec, s[28:29]
s_barrier
v_cmp_gt_u32 vcc, 53, v0
ds_read_b32 v5, v70
s_waitcnt lgkmcnt(0)
v_add_u32 v5, v5, v50
v_lshlrev_b32 v5, 3, v5
v_lshrrev_b32 v6, 9, v10
v_lshlrev_b32 v6, 20, v6
v_add_u32 v7, 0, v0
v_add_u32 v7, s24, v7
v_or_b32 v6, v6, v7
v_mov_b32 v7, v30
s_lshl_b32 s31, s24, 3
buffer_store_dwordx2 v[6:7], v5, s[20:23], s31 offen
ds_read_b32 v5, v71
s_waitcnt lgkmcnt(0)
v_add_u32 v5, v5, v51
v_lshlrev_b32 v5, 3, v5
v_lshrrev_b32 v6, 9, v11
v_lshlrev_b32 v6, 20, v6
v_add_u32 v7, 256, v0
v_add_u32 v7, s24, v7
v_or_b32 v6, v6, v7
v_mov_b32 v7, v31
s_lshl_b32 s31, s24, 3
buffer_store_dwordx2 v[6:7], v5, s[20:23], s31 offen
ds_read_b32 v5, v72
s_waitcnt lgkmcnt(0)
v_add_u32 v5, v5, v52
v_lshlrev_b32 v5, 3, v5
v_lshrrev_b32 v6, 9, v12
v_lshlrev_b32 v6, 20, v6
v_add_u32 v7, 512, v0
v_add_u32 v7, s24, v7
v_or_b32 v6, v6, v7
v_mov_b32 v7, v32
s_lshl_b32 s31, s24, 3
buffer_store_dwordx2 v[6:7], v5, s[20:23], s31 offen
ds_read_b32 v5, v73
s_waitcnt lgkmcnt(0)
v_add_u32 v5, v5, v53
v_lshlrev_b32 v5, 3, v5
v_lshrrev_b32 v6, 9, v13
v_lshlrev_b32 v6, 20, v6
v_add_u32 v7, 768, v0
v_add_u32 v7, s24, v7
v_or_b32 v6, v6, v7
v_mov_b32 v7, v33
s_lshl_b32 s31, s24, 3
buffer_store_dwordx2 v[6:7], v5, s[20:23], s31 offen
ds_read_b32 v5, v74
s_waitcnt lgkmcnt(0)
v_add_u32 v5, v5, v54
v_lshlrev_b32 v5, 3, v5
v_lshrrev_b32 v6, 9, v14
v_lshlrev_b32 v6, 20, v6
v_add_u32 v7, 1024, v0
v_add_u32 v7, s24, v7
v_or_b32 v6, v6, v7
v_mov_b32 v7, v34
s_lshl_b32 s31, s24, 3
buffer_store_dwordx2 v[6:7], v5, s[20:23], s31 offen
ds_read_b32 v5, v75
s_waitcnt lgkmcnt(0)
v_add_u32 v5, v5, v55
v_lshlrev_b32 v5, 3, v5
v_lshrrev_b32 v6, 9, v15
v_lshlrev_b32 v6, 20, v6
v_add_u32 v7, 1280, v0
v_add_u32 v7, s24, v7
v_or_b32 v6, v6, v7
v_mov_b32 v7, v35
s_lshl_b32 s31, s24, 3
buffer_store_dwordx2 v[6:7], v5, s[20:23], s31 offen
ds_read_b32 v5, v76
s_waitcnt lgkmcnt(0)
v_add_u32 v5, v5, v56
v_lshlrev_b32 v5, 3, v5
v_lshrrev_b32 v6, 9, v16
v_lshlrev_b32 v6, 20, v6
v_add_u32 v7, 1536, v0
v_add_u32 v7, s24, v7
v_or_b32 v6, v6, v7
v_mov_b32 v7, v36
s_lshl_b32 s31, s24, 3
buffer_store_dwordx2 v[6:7], v5, s[20:23], s31 offen
ds_read_b32 v5, v77
s_waitcnt lgkmcnt(0)
v_add_u32 v5, v5, v57
v_lshlrev_b32 v5, 3, v5
v_lshrrev_b32 v6, 9, v17
v_lshlrev_b32 v6, 20, v6
v_add_u32 v7, 1792, v0
v_add_u32 v7, s24, v7
v_or_b32 v6, v6, v7
v_mov_b32 v7, v37
s_lshl_b32 s31, s24, 3
buffer_store_dwordx2 v[6:7], v5, s[20:23], s31 offen
ds_read_b32 v5, v78
s_waitcnt lgkmcnt(0)
v_add_u32 v5, v5, v58
v_lshlrev_b32 v5, 3, v5
v_lshrrev_b32 v6, 9, v18
v_lshlrev_b32 v6, 20, v6
v_add_u32 v7, 2048, v0
v_add_u32 v7, s24, v7
v_or_b32 v6, v6, v7
v_mov_b32 v7, v38
s_lshl_b32 s31, s24, 3
buffer_store_dwordx2 v[6:7], v5, s[20:23], s31 offen
ds_read_b32 v5, v79
s_waitcnt lgkmcnt(0)
v_add_u32 v5, v5, v59
v_lshlrev_b32 v5, 3, v5
v_lshrrev_b32 v6, 9, v19
v_lshlrev_b32 v6, 20, v6
v_add_u32 v7, 2304, v0
v_add_u32 v7, s24, v7
v_or_b32 v6, v6, v7
v_mov_b32 v7, v39
s_lshl_b32 s31, s24, 3
buffer_store_dwordx2 v[6:7], v5, s[20:23], s31 offen
ds_read_b32 v5, v80
s_waitcnt lgkmcnt(0)
v_add_u32 v5, v5, v60
v_lshlrev_b32 v5, 3, v5
v_lshrrev_b32 v6, 9, v20
v_lshlrev_b32 v6, 20, v6
v_add_u32 v7, 2560, v0
v_add_u32 v7, s24, v7
v_or_b32 v6, v6, v7
v_mov_b32 v7, v40
s_lshl_b32 s31, s24, 3
buffer_store_dwordx2 v[6:7], v5, s[20:23], s31 offen
ds_read_b32 v5, v81
s_waitcnt lgkmcnt(0)
v_add_u32 v5, v5, v61
v_lshlrev_b32 v5, 3, v5
v_lshrrev_b32 v6, 9, v21
v_lshlrev_b32 v6, 20, v6
v_add_u32 v7, 2816, v0
v_add_u32 v7, s24, v7
v_or_b32 v6, v6, v7
v_mov_b32 v7, v41
s_lshl_b32 s31, s24, 3
buffer_store_dwordx2 v[6:7], v5, s[20:23], s31 offen
s_and_saveexec_b64 s[26:27], vcc
ds_read_b32 v5, v82
s_waitcnt lgkmcnt(0)
v_add_u32 v5, v5, v62
v_lshlrev_b32 v5, 3, v5
v_lshrrev_b32 v6, 9, v22
v_lshlrev_b32 v6, 20, v6
v_add_u32 v7, 3072, v0
v_add_u32 v7, s24, v7
v_or_b32 v6, v6, v7
v_mov_b32 v7, v42
s_lshl_b32 s31, s24, 3
buffer_store_dwordx2 v[6:7], v5, s[20:23], s31 offen
s_mov_b64 exec, s[26:27]
s_endpgm
P_FRAG:
s_load_dwordx8 s[4:11], s[0:1], 32
s_load_dwordx2 s[12:13], s[0:1], 64
s_load_dwordx2 s[14:15], s[0:1], 88
s_waitcnt lgkmcnt(0)
v_readfirstlane_b32 s16, v0
s_lshr_b32 s16, s16, 6
s_mov_b64 s[18:19], s[6:7]
s_cmp_eq_u32 s16, 1
s_cselect_b64 s[18:19], s[12:13], s[18:19]
s_cmp_eq_u32 s16, 2
s_cselect_b64 s[18:19], s[4:5], s[18:19]
s_cmp_eq_u32 s16, 3
s_cselect_b64 s[18:19], s[10:11], s[18:19]
s_mov_b32 s20, s18
s_mov_b32 s21, s19
s_mov_b32 s22, 8192
s_mov_b32 s23, 0x00020000
s_mov_b32 s24, s14
s_mov_b32 s25, s15
s_mov_b32 s26, 268435456
s_mov_b32 s27, 0x00020000
s_mov_b32 s28, s8
s_mov_b32 s29, s9
s_mov_b32 s30, 2048
s_mov_b32 s31, 0x00020000
v_and_b32 v1, 63, v0
v_and_b32 v2, 31, v1
v_lshrrev_b32 v3, 5, v1
v_lshlrev_b32 v4, 1, v2
v_lshlrev_b32 v5, 12, v3
v_add_u32 v5, v5, v4
v_lshlrev_b32 v6, 4, v1
s_lshl_b32 s17, s16, 13
s_add_u32 s17, s17, 12582912
v_add_u32 v7, 0, v5
buffer_load_ushort v32, v7, s[20:23], 0 offen
v_add_u32 v7, 128, v5
buffer_load_ushort v33, v7, s[20:23], 0 offen
v_add_u32 v7, 256, v5
buffer_load_ushort v34, v7, s[20:23], 0 offen
v_add_u32 v7, 384, v5
buffer_load_ushort v35, v7, s[20:23], 0 offen
v_add_u32 v7, 512, v5
buffer_load_ushort v36, v7, s[20:23], 0 offen
v_add_u32 v7, 640, v5
buffer_load_ushort v37, v7, s[20:23], 0 offen
v_add_u32 v7, 768, v5
buffer_load_ushort v38, v7, s[20:23], 0 offen
v_add_u32 v7, 896, v5
buffer_load_ushort v39, v7, s[20:23], 0 offen
v_add_u32 v7, 1024, v5
buffer_load_ushort v40, v7, s[20:23], 0 offen
v_add_u32 v7, 1152, v5
buffer_load_ushort v41, v7, s[20:23], 0 offen
v_add_u32 v7, 1280, v5
buffer_load_ushort v42, v7, s[20:23], 0 offen
v_add_u32 v7, 1408, v5
buffer_load_ushort v43, v7, s[20:23], 0 offen
v_add_u32 v7, 1536, v5
buffer_load_ushort v44, v7, s[20:23], 0 offen
v_add_u32 v7, 1664, v5
buffer_load_ushort v45, v7, s[20:23], 0 offen
v_add_u32 v7, 1792, v5
buffer_load_ushort v46, v7, s[20:23], 0 offen
v_add_u32 v7, 1920, v5
buffer_load_ushort v47, v7, s[20:23], 0 offen
v_add_u32 v7, 2048, v5
buffer_load_ushort v48, v7, s[20:23], 0 offen
v_add_u32 v7, 2176, v5
buffer_load_ushort v49, v7, s[20:23], 0 offen
v_add_u32 v7, 2304, v5
buffer_load_ushort v50, v7, s[20:23], 0 offen
v_add_u32 v7, 2432, v5
buffer_load_ushort v51, v7, s[20:23], 0 offen
v_add_u32 v7, 2560, v5
buffer_load_ushort v52, v7, s[20:23], 0 offen
v_add_u32 v7, 2688, v5
buffer_load_ushort v53, v7, s[20:23], 0 offen
v_add_u32 v7, 2816, v5
buffer_load_ushort v54, v7, s[20:23], 0 offen
v_add_u32 v7, 2944, v5
buffer_load_ushort v55, v7, s[20:23], 0 offen
v_add_u32 v7, 3072, v5
buffer_load_ushort v56, v7, s[20:23], 0 offen
v_add_u32 v7, 3200, v5
buffer_load_ushort v57, v7, s[20:23], 0 offen
v_add_u32 v7, 3328, v5
buffer_load_ushort v58, v7, s[20:23], 0 offen
v_add_u32 v7, 3456, v5
buffer_load_ushort v59, v7, s[20:23], 0 offen
v_add_u32 v7, 3584, v5
buffer_load_ushort v60, v7, s[20:23], 0 offen
v_add_u32 v7, 3712, v5
buffer_load_ushort v61, v7, s[20:23], 0 offen
v_add_u32 v7, 3840, v5
buffer_load_ushort v62, v7, s[20:23], 0 offen
v_add_u32 v7, 3968, v5
buffer_load_ushort v63, v7, s[20:23], 0 offen
v_add_u32 v7, 64, v5
buffer_load_ushort v64, v7, s[20:23], 0 offen
v_add_u32 v7, 192, v5
buffer_load_ushort v65, v7, s[20:23], 0 offen
v_add_u32 v7, 320, v5
buffer_load_ushort v66, v7, s[20:23], 0 offen
v_add_u32 v7, 448, v5
buffer_load_ushort v67, v7, s[20:23], 0 offen
v_add_u32 v7, 576, v5
buffer_load_ushort v68, v7, s[20:23], 0 offen
v_add_u32 v7, 704, v5
buffer_load_ushort v69, v7, s[20:23], 0 offen
v_add_u32 v7, 832, v5
buffer_load_ushort v70, v7, s[20:23], 0 offen
v_add_u32 v7, 960, v5
buffer_load_ushort v71, v7, s[20:23], 0 offen
v_add_u32 v7, 1088, v5
buffer_load_ushort v72, v7, s[20:23], 0 offen
v_add_u32 v7, 1216, v5
buffer_load_ushort v73, v7, s[20:23], 0 offen
v_add_u32 v7, 1344, v5
buffer_load_ushort v74, v7, s[20:23], 0 offen
v_add_u32 v7, 1472, v5
buffer_load_ushort v75, v7, s[20:23], 0 offen
v_add_u32 v7, 1600, v5
buffer_load_ushort v76, v7, s[20:23], 0 offen
v_add_u32 v7, 1728, v5
buffer_load_ushort v77, v7, s[20:23], 0 offen
v_add_u32 v7, 1856, v5
buffer_load_ushort v78, v7, s[20:23], 0 offen
v_add_u32 v7, 1984, v5
buffer_load_ushort v79, v7, s[20:23], 0 offen
v_add_u32 v7, 2112, v5
buffer_load_ushort v80, v7, s[20:23], 0 offen
v_add_u32 v7, 2240, v5
buffer_load_ushort v81, v7, s[20:23], 0 offen
v_add_u32 v7, 2368, v5
buffer_load_ushort v82, v7, s[20:23], 0 offen
v_add_u32 v7, 2496, v5
buffer_load_ushort v83, v7, s[20:23], 0 offen
v_add_u32 v7, 2624, v5
buffer_load_ushort v84, v7, s[20:23], 0 offen
v_add_u32 v7, 2752, v5
buffer_load_ushort v85, v7, s[20:23], 0 offen
v_add_u32 v7, 2880, v5
buffer_load_ushort v86, v7, s[20:23], 0 offen
v_add_u32 v7, 3008, v5
buffer_load_ushort v87, v7, s[20:23], 0 offen
v_add_u32 v7, 3136, v5
buffer_load_ushort v88, v7, s[20:23], 0 offen
v_add_u32 v7, 3264, v5
buffer_load_ushort v89, v7, s[20:23], 0 offen
v_add_u32 v7, 3392, v5
buffer_load_ushort v90, v7, s[20:23], 0 offen
v_add_u32 v7, 3520, v5
buffer_load_ushort v91, v7, s[20:23], 0 offen
v_add_u32 v7, 3648, v5
buffer_load_ushort v92, v7, s[20:23], 0 offen
v_add_u32 v7, 3776, v5
buffer_load_ushort v93, v7, s[20:23], 0 offen
v_add_u32 v7, 3904, v5
buffer_load_ushort v94, v7, s[20:23], 0 offen
v_add_u32 v7, 4032, v5
buffer_load_ushort v95, v7, s[20:23], 0 offen
s_waitcnt vmcnt(0)
v_lshl_or_b32 v20, v33, 16, v32
v_lshl_or_b32 v21, v35, 16, v34
v_lshl_or_b32 v22, v37, 16, v36
v_lshl_or_b32 v23, v39, 16, v38
v_add_u32 v7, 0, v6
buffer_store_dwordx4 v[20:23], v7, s[24:27], s17 offen
s_nop 1
v_lshl_or_b32 v20, v41, 16, v40
v_lshl_or_b32 v21, v43, 16, v42
v_lshl_or_b32 v22, v45, 16, v44
v_lshl_or_b32 v23, v47, 16, v46
v_add_u32 v7, 1024, v6
buffer_store_dwordx4 v[20:23], v7, s[24:27], s17 offen
s_nop 1
v_lshl_or_b32 v20, v49, 16, v48
v_lshl_or_b32 v21, v51, 16, v50
v_lshl_or_b32 v22, v53, 16, v52
v_lshl_or_b32 v23, v55, 16, v54
v_add_u32 v7, 2048, v6
buffer_store_dwordx4 v[20:23], v7, s[24:27], s17 offen
s_nop 1
v_lshl_or_b32 v20, v57, 16, v56
v_lshl_or_b32 v21, v59, 16, v58
v_lshl_or_b32 v22, v61, 16, v60
v_lshl_or_b32 v23, v63, 16, v62
v_add_u32 v7, 3072, v6
buffer_store_dwordx4 v[20:23], v7, s[24:27], s17 offen
s_nop 1
v_lshl_or_b32 v20, v65, 16, v64
v_lshl_or_b32 v21, v67, 16, v66
v_lshl_or_b32 v22, v69, 16, v68
v_lshl_or_b32 v23, v71, 16, v70
v_add_u32 v7, 4096, v6
buffer_store_dwordx4 v[20:23], v7, s[24:27], s17 offen
s_nop 1
v_lshl_or_b32 v20, v73, 16, v72
v_lshl_or_b32 v21, v75, 16, v74
v_lshl_or_b32 v22, v77, 16, v76
v_lshl_or_b32 v23, v79, 16, v78
v_add_u32 v7, 5120, v6
buffer_store_dwordx4 v[20:23], v7, s[24:27], s17 offen
s_nop 1
v_lshl_or_b32 v20, v81, 16, v80
v_lshl_or_b32 v21, v83, 16, v82
v_lshl_or_b32 v22, v85, 16, v84
v_lshl_or_b32 v23, v87, 16, v86
v_add_u32 v7, 6144, v6
buffer_store_dwordx4 v[20:23], v7, s[24:27], s17 offen
s_nop 1
v_lshl_or_b32 v20, v89, 16, v88
v_lshl_or_b32 v21, v91, 16, v90
v_lshl_or_b32 v22, v93, 16, v92
v_lshl_or_b32 v23, v95, 16, v94
v_add_u32 v7, 7168, v6
buffer_store_dwordx4 v[20:23], v7, s[24:27], s17 offen
s_nop 1
v_lshlrev_b32 v5, 10, v3
v_add_u32 v5, v5, v4
v_add_u32 v7, 0, v5
buffer_load_ushort v10, v7, s[28:31], 0 offen
v_add_u32 v7, 128, v5
buffer_load_ushort v11, v7, s[28:31], 0 offen
v_add_u32 v7, 256, v5
buffer_load_ushort v12, v7, s[28:31], 0 offen
v_add_u32 v7, 384, v5
buffer_load_ushort v13, v7, s[28:31], 0 offen
v_add_u32 v7, 512, v5
buffer_load_ushort v14, v7, s[28:31], 0 offen
v_add_u32 v7, 640, v5
buffer_load_ushort v15, v7, s[28:31], 0 offen
v_add_u32 v7, 768, v5
buffer_load_ushort v16, v7, s[28:31], 0 offen
v_add_u32 v7, 896, v5
buffer_load_ushort v17, v7, s[28:31], 0 offen
s_waitcnt vmcnt(0)
v_lshl_or_b32 v20, v11, 16, v10
v_lshl_or_b32 v21, v13, 16, v12
v_lshl_or_b32 v22, v15, 16, v14
v_lshl_or_b32 v23, v17, 16, v16
v_add_u32 v7, 12615680, v6
buffer_store_dwordx4 v[20:23], v7, s[24:27], 0 offen
v_add_u32 v7, 64, v5
buffer_load_ushort v10, v7, s[28:31], 0 offen
v_add_u32 v7, 192, v5
buffer_load_ushort v11, v7, s[28:31], 0 offen
v_add_u32 v7, 320, v5
buffer_load_ushort v12, v7, s[28:31], 0 offen
v_add_u32 v7, 448, v5
buffer_load_ushort v13, v7, s[28:31], 0 offen
v_add_u32 v7, 576, v5
buffer_load_ushort v14, v7, s[28:31], 0 offen
v_add_u32 v7, 704, v5
buffer_load_ushort v15, v7, s[28:31], 0 offen
v_add_u32 v7, 832, v5
buffer_load_ushort v16, v7, s[28:31], 0 offen
v_add_u32 v7, 960, v5
buffer_load_ushort v17, v7, s[28:31], 0 offen
s_waitcnt vmcnt(0)
v_lshl_or_b32 v20, v11, 16, v10
v_lshl_or_b32 v21, v13, 16, v12
v_lshl_or_b32 v22, v15, 16, v14
v_lshl_or_b32 v23, v17, 16, v16
v_add_u32 v7, 12616704, v6
buffer_store_dwordx4 v[20:23], v7, s[24:27], 0 offen
P_END:
s_endpgm
.section .rodata,"a"
.p2align 6
.amdhsa_kernel part_kernel
  .amdhsa_next_free_vgpr 128
  .amdhsa_next_free_sgpr 102
  .amdhsa_accum_offset 128
  .amdhsa_group_segment_fixed_size 0
  .amdhsa_kernarg_size 96
  .amdhsa_user_sgpr_count 2
  .amdhsa_user_sgpr_kernarg_segment_ptr 1
  .amdhsa_system_sgpr_workgroup_id_x 1
.end_amdhsa_kernel
.text
.globl main_kernel
.p2align 8
.type main_kernel,@function
main_kernel:
s_cmp_ge_u32 s2, 512
s_cbranch_scc1 M_END
s_load_dwordx4 s[4:7], s[0:1], 0
s_load_dwordx2 s[8:9], s[0:1], 72
s_load_dwordx2 s[10:11], s[0:1], 88
s_waitcnt lgkmcnt(0)
s_mov_b32 s12, s4
s_mov_b32 s13, s5
s_mov_b32 s14, 3200000
s_mov_b32 s15, 0x00020000
s_mov_b32 s16, s6
s_mov_b32 s17, s7
s_mov_b32 s18, 25600000
s_mov_b32 s19, 0x00020000
s_mov_b32 s20, s8
s_mov_b32 s21, s9
s_mov_b32 s22, 3200000
s_mov_b32 s23, 0x00020000
s_mov_b32 s24, s10
s_mov_b32 s25, s11
s_mov_b32 s26, 268435456
s_mov_b32 s27, 0x00020000
v_and_b32 v1, 63, v0
v_and_b32 v2, 31, v1
v_lshlrev_b32 v2, 2, v2
v_lshrrev_b32 v3, 5, v1
v_readfirstlane_b32 s28, v0
s_lshr_b32 s28, s28, 6
v_lshlrev_b32 v4, 4, v0
v_mov_b32 v240, 0
v_mov_b32 v241, 0
v_mov_b32 v242, 0
v_mov_b32 v243, 0
ds_write_b128 v4, v[240:243] offset:0
ds_write_b128 v4, v[240:243] offset:4096
ds_write_b128 v4, v[240:243] offset:8192
ds_write_b128 v4, v[240:243] offset:12288
ds_write_b128 v4, v[240:243] offset:16384
ds_write_b128 v4, v[240:243] offset:20480
ds_write_b128 v4, v[240:243] offset:24576
ds_write_b128 v4, v[240:243] offset:28672
ds_write_b128 v4, v[240:243] offset:32768
v_cmp_gt_u32 vcc, 48, v0
s_and_saveexec_b64 s[30:31], vcc
ds_write_b128 v4, v[240:243] offset:36864
s_mov_b64 exec, s[30:31]
ds_write_b32 v2, v240 offset:38144
v_mul_u32_u24 v5, 2080, v0
s_lshl_b32 s29, s2, 2
s_add_u32 s29, s29, 8388608
buffer_load_dwordx2 v[6:7], v5, s[24:27], s29 offen
s_waitcnt vmcnt(0) lgkmcnt(0)
s_barrier
v_sub_u32 v7, v7, v6
v_mov_b32 v8, 38144
ds_max_u32 v8, v7
v_mul_u32_u24 v9, 3125, v0
v_add_u32 v9, v9, v6
v_lshlrev_b32 v9, 3, v9
s_cmp_ge_u32 s28, 2
s_cbranch_scc1 M_NOA
s_lshl_b32 s32, s28, 5
v_and_b32 v10, 31, v1
v_add_u32 v10, s32, v10
v_lshlrev_b32 v10, 9, v10
v_add_u32 v10, s2, v10
v_lshlrev_b32 v10, 7, v10
v_lshl_add_u32 v10, v3, 6, v10
buffer_load_dwordx4 v[204:207], v10, s[12:15], 0 offen offset:0
buffer_load_dwordx4 v[208:211], v10, s[12:15], 0 offen offset:16
buffer_load_dwordx4 v[212:215], v10, s[12:15], 0 offen offset:32
buffer_load_dwordx4 v[216:219], v10, s[12:15], 0 offen offset:48
v_lshlrev_b32 v11, 4, v1
v_add_u32 v12, 12599296, v11
buffer_load_dwordx4 v[64:67], v12, s[24:27], 0 offen
v_add_u32 v12, 12600320, v11
buffer_load_dwordx4 v[68:71], v12, s[24:27], 0 offen
v_add_u32 v12, 12601344, v11
buffer_load_dwordx4 v[72:75], v12, s[24:27], 0 offen
v_add_u32 v12, 12602368, v11
buffer_load_dwordx4 v[76:79], v12, s[24:27], 0 offen
v_add_u32 v12, 12603392, v11
buffer_load_dwordx4 v[80:83], v12, s[24:27], 0 offen
v_add_u32 v12, 12604416, v11
buffer_load_dwordx4 v[84:87], v12, s[24:27], 0 offen
v_add_u32 v12, 12605440, v11
buffer_load_dwordx4 v[88:91], v12, s[24:27], 0 offen
v_add_u32 v12, 12606464, v11
buffer_load_dwordx4 v[92:95], v12, s[24:27], 0 offen
s_waitcnt vmcnt(0)
v_mfma_f32_32x32x16_bf16 v[140:155], v[204:207], v[64:67], 0
v_mfma_f32_32x32x16_bf16 v[140:155], v[208:211], v[68:71], v[140:155]
v_mfma_f32_32x32x16_bf16 v[140:155], v[212:215], v[72:75], v[140:155]
v_mfma_f32_32x32x16_bf16 v[140:155], v[216:219], v[76:79], v[140:155]
v_mfma_f32_32x32x16_bf16 v[156:171], v[204:207], v[80:83], 0
v_mfma_f32_32x32x16_bf16 v[156:171], v[208:211], v[84:87], v[156:171]
v_mfma_f32_32x32x16_bf16 v[156:171], v[212:215], v[88:91], v[156:171]
v_mfma_f32_32x32x16_bf16 v[156:171], v[216:219], v[92:95], v[156:171]
s_nop 15
s_nop 3
v_lshl_add_u32 v13, v3, 2, s32
s_mov_b32 s33, 0xbfb8aa3b
v_add_u32 v14, 0, v13
v_cmp_gt_u32 vcc, 49, v14
s_and_saveexec_b64 s[30:31], vcc
v_mul_u32_u24 v15, 768, v14
v_add_u32 v15, v15, v2
v_mul_f32 v16, s33, v140
ds_write_b32 v15, v16 offset:512
s_mov_b64 exec, s[30:31]
v_add_u32 v14, 1, v13
v_cmp_gt_u32 vcc, 49, v14
s_and_saveexec_b64 s[30:31], vcc
v_mul_u32_u24 v15, 768, v14
v_add_u32 v15, v15, v2
v_mul_f32 v16, s33, v141
ds_write_b32 v15, v16 offset:512
s_mov_b64 exec, s[30:31]
v_add_u32 v14, 2, v13
v_cmp_gt_u32 vcc, 49, v14
s_and_saveexec_b64 s[30:31], vcc
v_mul_u32_u24 v15, 768, v14
v_add_u32 v15, v15, v2
v_mul_f32 v16, s33, v142
ds_write_b32 v15, v16 offset:512
s_mov_b64 exec, s[30:31]
v_add_u32 v14, 3, v13
v_cmp_gt_u32 vcc, 49, v14
s_and_saveexec_b64 s[30:31], vcc
v_mul_u32_u24 v15, 768, v14
v_add_u32 v15, v15, v2
v_mul_f32 v16, s33, v143
ds_write_b32 v15, v16 offset:512
s_mov_b64 exec, s[30:31]
v_add_u32 v14, 8, v13
v_cmp_gt_u32 vcc, 49, v14
s_and_saveexec_b64 s[30:31], vcc
v_mul_u32_u24 v15, 768, v14
v_add_u32 v15, v15, v2
v_mul_f32 v16, s33, v144
ds_write_b32 v15, v16 offset:512
s_mov_b64 exec, s[30:31]
v_add_u32 v14, 9, v13
v_cmp_gt_u32 vcc, 49, v14
s_and_saveexec_b64 s[30:31], vcc
v_mul_u32_u24 v15, 768, v14
v_add_u32 v15, v15, v2
v_mul_f32 v16, s33, v145
ds_write_b32 v15, v16 offset:512
s_mov_b64 exec, s[30:31]
v_add_u32 v14, 10, v13
v_cmp_gt_u32 vcc, 49, v14
s_and_saveexec_b64 s[30:31], vcc
v_mul_u32_u24 v15, 768, v14
v_add_u32 v15, v15, v2
v_mul_f32 v16, s33, v146
ds_write_b32 v15, v16 offset:512
s_mov_b64 exec, s[30:31]
v_add_u32 v14, 11, v13
v_cmp_gt_u32 vcc, 49, v14
s_and_saveexec_b64 s[30:31], vcc
v_mul_u32_u24 v15, 768, v14
v_add_u32 v15, v15, v2
v_mul_f32 v16, s33, v147
ds_write_b32 v15, v16 offset:512
s_mov_b64 exec, s[30:31]
v_add_u32 v14, 16, v13
v_cmp_gt_u32 vcc, 49, v14
s_and_saveexec_b64 s[30:31], vcc
v_mul_u32_u24 v15, 768, v14
v_add_u32 v15, v15, v2
v_mul_f32 v16, s33, v148
ds_write_b32 v15, v16 offset:512
s_mov_b64 exec, s[30:31]
v_add_u32 v14, 17, v13
v_cmp_gt_u32 vcc, 49, v14
s_and_saveexec_b64 s[30:31], vcc
v_mul_u32_u24 v15, 768, v14
v_add_u32 v15, v15, v2
v_mul_f32 v16, s33, v149
ds_write_b32 v15, v16 offset:512
s_mov_b64 exec, s[30:31]
v_add_u32 v14, 18, v13
v_cmp_gt_u32 vcc, 49, v14
s_and_saveexec_b64 s[30:31], vcc
v_mul_u32_u24 v15, 768, v14
v_add_u32 v15, v15, v2
v_mul_f32 v16, s33, v150
ds_write_b32 v15, v16 offset:512
s_mov_b64 exec, s[30:31]
v_add_u32 v14, 19, v13
v_cmp_gt_u32 vcc, 49, v14
s_and_saveexec_b64 s[30:31], vcc
v_mul_u32_u24 v15, 768, v14
v_add_u32 v15, v15, v2
v_mul_f32 v16, s33, v151
ds_write_b32 v15, v16 offset:512
s_mov_b64 exec, s[30:31]
v_add_u32 v14, 24, v13
v_cmp_gt_u32 vcc, 49, v14
s_and_saveexec_b64 s[30:31], vcc
v_mul_u32_u24 v15, 768, v14
v_add_u32 v15, v15, v2
v_mul_f32 v16, s33, v152
ds_write_b32 v15, v16 offset:512
s_mov_b64 exec, s[30:31]
v_add_u32 v14, 25, v13
v_cmp_gt_u32 vcc, 49, v14
s_and_saveexec_b64 s[30:31], vcc
v_mul_u32_u24 v15, 768, v14
v_add_u32 v15, v15, v2
v_mul_f32 v16, s33, v153
ds_write_b32 v15, v16 offset:512
s_mov_b64 exec, s[30:31]
v_add_u32 v14, 26, v13
v_cmp_gt_u32 vcc, 49, v14
s_and_saveexec_b64 s[30:31], vcc
v_mul_u32_u24 v15, 768, v14
v_add_u32 v15, v15, v2
v_mul_f32 v16, s33, v154
ds_write_b32 v15, v16 offset:512
s_mov_b64 exec, s[30:31]
v_add_u32 v14, 27, v13
v_cmp_gt_u32 vcc, 49, v14
s_and_saveexec_b64 s[30:31], vcc
v_mul_u32_u24 v15, 768, v14
v_add_u32 v15, v15, v2
v_mul_f32 v16, s33, v155
ds_write_b32 v15, v16 offset:512
s_mov_b64 exec, s[30:31]
v_add_u32 v14, 0, v13
v_cmp_gt_u32 vcc, 49, v14
s_and_saveexec_b64 s[30:31], vcc
v_mul_u32_u24 v15, 768, v14
v_add_u32 v15, v15, v2
v_mul_f32 v16, s33, v156
ds_write_b32 v15, v16 offset:640
s_mov_b64 exec, s[30:31]
v_add_u32 v14, 1, v13
v_cmp_gt_u32 vcc, 49, v14
s_and_saveexec_b64 s[30:31], vcc
v_mul_u32_u24 v15, 768, v14
v_add_u32 v15, v15, v2
v_mul_f32 v16, s33, v157
ds_write_b32 v15, v16 offset:640
s_mov_b64 exec, s[30:31]
v_add_u32 v14, 2, v13
v_cmp_gt_u32 vcc, 49, v14
s_and_saveexec_b64 s[30:31], vcc
v_mul_u32_u24 v15, 768, v14
v_add_u32 v15, v15, v2
v_mul_f32 v16, s33, v158
ds_write_b32 v15, v16 offset:640
s_mov_b64 exec, s[30:31]
v_add_u32 v14, 3, v13
v_cmp_gt_u32 vcc, 49, v14
s_and_saveexec_b64 s[30:31], vcc
v_mul_u32_u24 v15, 768, v14
v_add_u32 v15, v15, v2
v_mul_f32 v16, s33, v159
ds_write_b32 v15, v16 offset:640
s_mov_b64 exec, s[30:31]
v_add_u32 v14, 8, v13
v_cmp_gt_u32 vcc, 49, v14
s_and_saveexec_b64 s[30:31], vcc
v_mul_u32_u24 v15, 768, v14
v_add_u32 v15, v15, v2
v_mul_f32 v16, s33, v160
ds_write_b32 v15, v16 offset:640
s_mov_b64 exec, s[30:31]
v_add_u32 v14, 9, v13
v_cmp_gt_u32 vcc, 49, v14
s_and_saveexec_b64 s[30:31], vcc
v_mul_u32_u24 v15, 768, v14
v_add_u32 v15, v15, v2
v_mul_f32 v16, s33, v161
ds_write_b32 v15, v16 offset:640
s_mov_b64 exec, s[30:31]
v_add_u32 v14, 10, v13
v_cmp_gt_u32 vcc, 49, v14
s_and_saveexec_b64 s[30:31], vcc
v_mul_u32_u24 v15, 768, v14
v_add_u32 v15, v15, v2
v_mul_f32 v16, s33, v162
ds_write_b32 v15, v16 offset:640
s_mov_b64 exec, s[30:31]
v_add_u32 v14, 11, v13
v_cmp_gt_u32 vcc, 49, v14
s_and_saveexec_b64 s[30:31], vcc
v_mul_u32_u24 v15, 768, v14
v_add_u32 v15, v15, v2
v_mul_f32 v16, s33, v163
ds_write_b32 v15, v16 offset:640
s_mov_b64 exec, s[30:31]
v_add_u32 v14, 16, v13
v_cmp_gt_u32 vcc, 49, v14
s_and_saveexec_b64 s[30:31], vcc
v_mul_u32_u24 v15, 768, v14
v_add_u32 v15, v15, v2
v_mul_f32 v16, s33, v164
ds_write_b32 v15, v16 offset:640
s_mov_b64 exec, s[30:31]
v_add_u32 v14, 17, v13
v_cmp_gt_u32 vcc, 49, v14
s_and_saveexec_b64 s[30:31], vcc
v_mul_u32_u24 v15, 768, v14
v_add_u32 v15, v15, v2
v_mul_f32 v16, s33, v165
ds_write_b32 v15, v16 offset:640
s_mov_b64 exec, s[30:31]
v_add_u32 v14, 18, v13
v_cmp_gt_u32 vcc, 49, v14
s_and_saveexec_b64 s[30:31], vcc
v_mul_u32_u24 v15, 768, v14
v_add_u32 v15, v15, v2
v_mul_f32 v16, s33, v166
ds_write_b32 v15, v16 offset:640
s_mov_b64 exec, s[30:31]
v_add_u32 v14, 19, v13
v_cmp_gt_u32 vcc, 49, v14
s_and_saveexec_b64 s[30:31], vcc
v_mul_u32_u24 v15, 768, v14
v_add_u32 v15, v15, v2
v_mul_f32 v16, s33, v167
ds_write_b32 v15, v16 offset:640
s_mov_b64 exec, s[30:31]
v_add_u32 v14, 24, v13
v_cmp_gt_u32 vcc, 49, v14
s_and_saveexec_b64 s[30:31], vcc
v_mul_u32_u24 v15, 768, v14
v_add_u32 v15, v15, v2
v_mul_f32 v16, s33, v168
ds_write_b32 v15, v16 offset:640
s_mov_b64 exec, s[30:31]
v_add_u32 v14, 25, v13
v_cmp_gt_u32 vcc, 49, v14
s_and_saveexec_b64 s[30:31], vcc
v_mul_u32_u24 v15, 768, v14
v_add_u32 v15, v15, v2
v_mul_f32 v16, s33, v169
ds_write_b32 v15, v16 offset:640
s_mov_b64 exec, s[30:31]
v_add_u32 v14, 26, v13
v_cmp_gt_u32 vcc, 49, v14
s_and_saveexec_b64 s[30:31], vcc
v_mul_u32_u24 v15, 768, v14
v_add_u32 v15, v15, v2
v_mul_f32 v16, s33, v170
ds_write_b32 v15, v16 offset:640
s_mov_b64 exec, s[30:31]
v_add_u32 v14, 27, v13
v_cmp_gt_u32 vcc, 49, v14
s_and_saveexec_b64 s[30:31], vcc
v_mul_u32_u24 v15, 768, v14
v_add_u32 v15, v15, v2
v_mul_f32 v16, s33, v171
ds_write_b32 v15, v16 offset:640
s_mov_b64 exec, s[30:31]
M_NOA:
v_lshlrev_b32 v11, 4, v1
v_add_u32 v12, 12582912, v11
buffer_load_dwordx4 v[64:67], v12, s[24:27], 0 offen
v_add_u32 v12, 12583936, v11
buffer_load_dwordx4 v[68:71], v12, s[24:27], 0 offen
v_add_u32 v12, 12584960, v11
buffer_load_dwordx4 v[72:75], v12, s[24:27], 0 offen
v_add_u32 v12, 12585984, v11
buffer_load_dwordx4 v[76:79], v12, s[24:27], 0 offen
v_add_u32 v12, 12587008, v11
buffer_load_dwordx4 v[80:83], v12, s[24:27], 0 offen
v_add_u32 v12, 12588032, v11
buffer_load_dwordx4 v[84:87], v12, s[24:27], 0 offen
v_add_u32 v12, 12589056, v11
buffer_load_dwordx4 v[88:91], v12, s[24:27], 0 offen
v_add_u32 v12, 12590080, v11
buffer_load_dwordx4 v[92:95], v12, s[24:27], 0 offen
v_add_u32 v12, 12591104, v11
buffer_load_dwordx4 v[96:99], v12, s[24:27], 0 offen
v_add_u32 v12, 12592128, v11
buffer_load_dwordx4 v[100:103], v12, s[24:27], 0 offen
v_add_u32 v12, 12593152, v11
buffer_load_dwordx4 v[104:107], v12, s[24:27], 0 offen
v_add_u32 v12, 12594176, v11
buffer_load_dwordx4 v[108:111], v12, s[24:27], 0 offen
v_add_u32 v12, 12595200, v11
buffer_load_dwordx4 v[112:115], v12, s[24:27], 0 offen
v_add_u32 v12, 12596224, v11
buffer_load_dwordx4 v[116:119], v12, s[24:27], 0 offen
v_add_u32 v12, 12597248, v11
buffer_load_dwordx4 v[120:123], v12, s[24:27], 0 offen
v_add_u32 v12, 12598272, v11
buffer_load_dwordx4 v[124:127], v12, s[24:27], 0 offen
v_add_u32 v12, 12615680, v11
buffer_load_dwordx4 v[128:131], v12, s[24:27], 0 offen
v_add_u32 v12, 12616704, v11
buffer_load_dwordx4 v[132:135], v12, s[24:27], 0 offen
v_mov_b32 v136, 0xc6ea
v_cmp_eq_u32 vcc, 0, v3
v_cndmask_b32 v136, 0, v136, vcc
v_mov_b32 v137, 0
v_mov_b32 v138, 0
v_mov_b32 v139, 0
v_mov_b32 v225, 0
v_mov_b32 v226, 0
v_mov_b32 v227, 0
s_waitcnt lgkmcnt(0)
s_barrier
ds_read_b32 v8, v8
s_waitcnt lgkmcnt(0)
v_readfirstlane_b32 s34, v8
s_add_u32 s34, s34, 15
s_lshr_b32 s34, s34, 4
s_mov_b32 s35, 0
M_BATCH:
s_cmp_ge_u32 s35, s34
s_cbranch_scc1 M_FIN
v_lshlrev_b32 v17, 2, v0
v_cmp_gt_u32 vcc, 64, v0
s_and_saveexec_b64 s[30:31], vcc
ds_write_b32 v17, v240 offset:37632
s_mov_b64 exec, s[30:31]
s_waitcnt lgkmcnt(0)
s_barrier
s_lshl_b32 s36, s35, 4
v_subrev_u32 v18, s36, v7
s_lshl_b32 s37, s36, 3
v_cmp_lt_i32 vcc, 0, v18
s_and_saveexec_b64 s[30:31], vcc
buffer_load_dwordx2 v[140:141], v9, s[24:27], s37 offen offset:0
s_mov_b64 exec, s[30:31]
v_cmp_lt_i32 vcc, 1, v18
s_and_saveexec_b64 s[30:31], vcc
buffer_load_dwordx2 v[142:143], v9, s[24:27], s37 offen offset:8
s_mov_b64 exec, s[30:31]
v_cmp_lt_i32 vcc, 2, v18
s_and_saveexec_b64 s[30:31], vcc
buffer_load_dwordx2 v[144:145], v9, s[24:27], s37 offen offset:16
s_mov_b64 exec, s[30:31]
v_cmp_lt_i32 vcc, 3, v18
s_and_saveexec_b64 s[30:31], vcc
buffer_load_dwordx2 v[146:147], v9, s[24:27], s37 offen offset:24
s_mov_b64 exec, s[30:31]
v_cmp_lt_i32 vcc, 4, v18
s_and_saveexec_b64 s[30:31], vcc
buffer_load_dwordx2 v[148:149], v9, s[24:27], s37 offen offset:32
s_mov_b64 exec, s[30:31]
v_cmp_lt_i32 vcc, 5, v18
s_and_saveexec_b64 s[30:31], vcc
buffer_load_dwordx2 v[150:151], v9, s[24:27], s37 offen offset:40
s_mov_b64 exec, s[30:31]
v_cmp_lt_i32 vcc, 6, v18
s_and_saveexec_b64 s[30:31], vcc
buffer_load_dwordx2 v[152:153], v9, s[24:27], s37 offen offset:48
s_mov_b64 exec, s[30:31]
v_cmp_lt_i32 vcc, 7, v18
s_and_saveexec_b64 s[30:31], vcc
buffer_load_dwordx2 v[154:155], v9, s[24:27], s37 offen offset:56
s_mov_b64 exec, s[30:31]
v_cmp_lt_i32 vcc, 8, v18
s_and_saveexec_b64 s[30:31], vcc
buffer_load_dwordx2 v[156:157], v9, s[24:27], s37 offen offset:64
s_mov_b64 exec, s[30:31]
v_cmp_lt_i32 vcc, 9, v18
s_and_saveexec_b64 s[30:31], vcc
buffer_load_dwordx2 v[158:159], v9, s[24:27], s37 offen offset:72
s_mov_b64 exec, s[30:31]
v_cmp_lt_i32 vcc, 10, v18
s_and_saveexec_b64 s[30:31], vcc
buffer_load_dwordx2 v[160:161], v9, s[24:27], s37 offen offset:80
s_mov_b64 exec, s[30:31]
v_cmp_lt_i32 vcc, 11, v18
s_and_saveexec_b64 s[30:31], vcc
buffer_load_dwordx2 v[162:163], v9, s[24:27], s37 offen offset:88
s_mov_b64 exec, s[30:31]
v_cmp_lt_i32 vcc, 12, v18
s_and_saveexec_b64 s[30:31], vcc
buffer_load_dwordx2 v[164:165], v9, s[24:27], s37 offen offset:96
s_mov_b64 exec, s[30:31]
v_cmp_lt_i32 vcc, 13, v18
s_and_saveexec_b64 s[30:31], vcc
buffer_load_dwordx2 v[166:167], v9, s[24:27], s37 offen offset:104
s_mov_b64 exec, s[30:31]
v_cmp_lt_i32 vcc, 14, v18
s_and_saveexec_b64 s[30:31], vcc
buffer_load_dwordx2 v[168:169], v9, s[24:27], s37 offen offset:112
s_mov_b64 exec, s[30:31]
v_cmp_lt_i32 vcc, 15, v18
s_and_saveexec_b64 s[30:31], vcc
buffer_load_dwordx2 v[170:171], v9, s[24:27], s37 offen offset:120
s_mov_b64 exec, s[30:31]
s_waitcnt vmcnt(0)
v_mov_b32 v19, 1
v_cmp_lt_i32 vcc, 0, v18
s_and_saveexec_b64 s[30:31], vcc
v_bfe_u32 v20, v140, 20, 6
v_lshlrev_b32 v188, 2, v20
ds_add_rtn_u32 v172, v188, v19 offset:37632
s_mov_b64 exec, s[30:31]
v_cmp_lt_i32 vcc, 1, v18
s_and_saveexec_b64 s[30:31], vcc
v_bfe_u32 v20, v142, 20, 6
v_lshlrev_b32 v189, 2, v20
ds_add_rtn_u32 v173, v189, v19 offset:37632
s_mov_b64 exec, s[30:31]
v_cmp_lt_i32 vcc, 2, v18
s_and_saveexec_b64 s[30:31], vcc
v_bfe_u32 v20, v144, 20, 6
v_lshlrev_b32 v190, 2, v20
ds_add_rtn_u32 v174, v190, v19 offset:37632
s_mov_b64 exec, s[30:31]
v_cmp_lt_i32 vcc, 3, v18
s_and_saveexec_b64 s[30:31], vcc
v_bfe_u32 v20, v146, 20, 6
v_lshlrev_b32 v191, 2, v20
ds_add_rtn_u32 v175, v191, v19 offset:37632
s_mov_b64 exec, s[30:31]
v_cmp_lt_i32 vcc, 4, v18
s_and_saveexec_b64 s[30:31], vcc
v_bfe_u32 v20, v148, 20, 6
v_lshlrev_b32 v192, 2, v20
ds_add_rtn_u32 v176, v192, v19 offset:37632
s_mov_b64 exec, s[30:31]
v_cmp_lt_i32 vcc, 5, v18
s_and_saveexec_b64 s[30:31], vcc
v_bfe_u32 v20, v150, 20, 6
v_lshlrev_b32 v193, 2, v20
ds_add_rtn_u32 v177, v193, v19 offset:37632
s_mov_b64 exec, s[30:31]
v_cmp_lt_i32 vcc, 6, v18
s_and_saveexec_b64 s[30:31], vcc
v_bfe_u32 v20, v152, 20, 6
v_lshlrev_b32 v194, 2, v20
ds_add_rtn_u32 v178, v194, v19 offset:37632
s_mov_b64 exec, s[30:31]
v_cmp_lt_i32 vcc, 7, v18
s_and_saveexec_b64 s[30:31], vcc
v_bfe_u32 v20, v154, 20, 6
v_lshlrev_b32 v195, 2, v20
ds_add_rtn_u32 v179, v195, v19 offset:37632
s_mov_b64 exec, s[30:31]
v_cmp_lt_i32 vcc, 8, v18
s_and_saveexec_b64 s[30:31], vcc
v_bfe_u32 v20, v156, 20, 6
v_lshlrev_b32 v196, 2, v20
ds_add_rtn_u32 v180, v196, v19 offset:37632
s_mov_b64 exec, s[30:31]
v_cmp_lt_i32 vcc, 9, v18
s_and_saveexec_b64 s[30:31], vcc
v_bfe_u32 v20, v158, 20, 6
v_lshlrev_b32 v197, 2, v20
ds_add_rtn_u32 v181, v197, v19 offset:37632
s_mov_b64 exec, s[30:31]
v_cmp_lt_i32 vcc, 10, v18
s_and_saveexec_b64 s[30:31], vcc
v_bfe_u32 v20, v160, 20, 6
v_lshlrev_b32 v198, 2, v20
ds_add_rtn_u32 v182, v198, v19 offset:37632
s_mov_b64 exec, s[30:31]
v_cmp_lt_i32 vcc, 11, v18
s_and_saveexec_b64 s[30:31], vcc
v_bfe_u32 v20, v162, 20, 6
v_lshlrev_b32 v199, 2, v20
ds_add_rtn_u32 v183, v199, v19 offset:37632
s_mov_b64 exec, s[30:31]
v_cmp_lt_i32 vcc, 12, v18
s_and_saveexec_b64 s[30:31], vcc
v_bfe_u32 v20, v164, 20, 6
v_lshlrev_b32 v200, 2, v20
ds_add_rtn_u32 v184, v200, v19 offset:37632
s_mov_b64 exec, s[30:31]
v_cmp_lt_i32 vcc, 13, v18
s_and_saveexec_b64 s[30:31], vcc
v_bfe_u32 v20, v166, 20, 6
v_lshlrev_b32 v201, 2, v20
ds_add_rtn_u32 v185, v201, v19 offset:37632
s_mov_b64 exec, s[30:31]
v_cmp_lt_i32 vcc, 14, v18
s_and_saveexec_b64 s[30:31], vcc
v_bfe_u32 v20, v168, 20, 6
v_lshlrev_b32 v202, 2, v20
ds_add_rtn_u32 v186, v202, v19 offset:37632
s_mov_b64 exec, s[30:31]
v_cmp_lt_i32 vcc, 15, v18
s_and_saveexec_b64 s[30:31], vcc
v_bfe_u32 v20, v170, 20, 6
v_lshlrev_b32 v203, 2, v20
ds_add_rtn_u32 v187, v203, v19 offset:37632
s_mov_b64 exec, s[30:31]
s_waitcnt lgkmcnt(0)
s_barrier
v_cmp_gt_u32 vcc, 64, v0
s_and_saveexec_b64 s[38:39], vcc
s_cbranch_execz M_S2
ds_read_b32 v20, v17 offset:37632
s_waitcnt lgkmcnt(0)
v_add_u32 v21, 7, v20
v_and_b32 v21, -8, v21
v_mov_b32 v22, v21
s_nop 1
v_add_u32_dpp v21, v21, v21 row_shr:1 row_mask:0xf bank_mask:0xf bound_ctrl:0
s_nop 1
v_add_u32_dpp v21, v21, v21 row_shr:2 row_mask:0xf bank_mask:0xf bound_ctrl:0
s_nop 1
v_add_u32_dpp v21, v21, v21 row_shr:4 row_mask:0xf bank_mask:0xf bound_ctrl:0
s_nop 1
v_add_u32_dpp v21, v21, v21 row_shr:8 row_mask:0xf bank_mask:0xf bound_ctrl:0
s_nop 1
v_add_u32_dpp v21, v21, v21 row_bcast:15 row_mask:0xa bank_mask:0xf
s_nop 1
v_add_u32_dpp v21, v21, v21 row_bcast:31 row_mask:0xc bank_mask:0xf
s_nop 1
v_sub_u32 v23, v21, v22
ds_write_b32 v17, v23 offset:37888
v_lshlrev_b32 v24, 20, v0
v_or_b32 v24, 0x80000000, v24
v_mov_b32 v25, 0
v_add_u32 v26, v23, v20
v_add_u32 v27, 0, v20
v_cmp_gt_u32 vcc, v22, v27
s_and_saveexec_b64 s[30:31], vcc
v_add_u32 v28, 0, v26
v_lshlrev_b32 v28, 3, v28
ds_write_b64 v28, v[24:25] offset:38208
s_mov_b64 exec, s[30:31]
v_add_u32 v27, 1, v20
v_cmp_gt_u32 vcc, v22, v27
s_and_saveexec_b64 s[30:31], vcc
v_add_u32 v28, 1, v26
v_lshlrev_b32 v28, 3, v28
ds_write_b64 v28, v[24:25] offset:38208
s_mov_b64 exec, s[30:31]
v_add_u32 v27, 2, v20
v_cmp_gt_u32 vcc, v22, v27
s_and_saveexec_b64 s[30:31], vcc
v_add_u32 v28, 2, v26
v_lshlrev_b32 v28, 3, v28
ds_write_b64 v28, v[24:25] offset:38208
s_mov_b64 exec, s[30:31]
v_add_u32 v27, 3, v20
v_cmp_gt_u32 vcc, v22, v27
s_and_saveexec_b64 s[30:31], vcc
v_add_u32 v28, 3, v26
v_lshlrev_b32 v28, 3, v28
ds_write_b64 v28, v[24:25] offset:38208
s_mov_b64 exec, s[30:31]
v_add_u32 v27, 4, v20
v_cmp_gt_u32 vcc, v22, v27
s_and_saveexec_b64 s[30:31], vcc
v_add_u32 v28, 4, v26
v_lshlrev_b32 v28, 3, v28
ds_write_b64 v28, v[24:25] offset:38208
s_mov_b64 exec, s[30:31]
v_add_u32 v27, 5, v20
v_cmp_gt_u32 vcc, v22, v27
s_and_saveexec_b64 s[30:31], vcc
v_add_u32 v28, 5, v26
v_lshlrev_b32 v28, 3, v28
ds_write_b64 v28, v[24:25] offset:38208
s_mov_b64 exec, s[30:31]
v_add_u32 v27, 6, v20
v_cmp_gt_u32 vcc, v22, v27
s_and_saveexec_b64 s[30:31], vcc
v_add_u32 v28, 6, v26
v_lshlrev_b32 v28, 3, v28
ds_write_b64 v28, v[24:25] offset:38208
s_mov_b64 exec, s[30:31]
v_readlane_b32 s40, v21, 63
s_nop 3
v_add_u32 v28, s40, v0
v_lshlrev_b32 v28, 3, v28
v_mov_b32 v24, 0x80000000
ds_write_b64 v28, v[24:25] offset:38208
v_mov_b32 v29, s40
v_mov_b32 v30, 38144
ds_write_b32 v30, v29 offset:4
s_waitcnt lgkmcnt(0)
M_S2:
s_mov_b64 exec, s[38:39]
s_barrier
v_cmp_lt_i32 vcc, 0, v18
s_and_saveexec_b64 s[30:31], vcc
ds_read_b32 v20, v188 offset:37888
s_waitcnt lgkmcnt(0)
v_add_u32 v20, v20, v172
v_lshlrev_b32 v20, 3, v20
ds_write_b64 v20, v[140:141] offset:38208
s_mov_b64 exec, s[30:31]
v_cmp_lt_i32 vcc, 1, v18
s_and_saveexec_b64 s[30:31], vcc
ds_read_b32 v20, v189 offset:37888
s_waitcnt lgkmcnt(0)
v_add_u32 v20, v20, v173
v_lshlrev_b32 v20, 3, v20
ds_write_b64 v20, v[142:143] offset:38208
s_mov_b64 exec, s[30:31]
v_cmp_lt_i32 vcc, 2, v18
s_and_saveexec_b64 s[30:31], vcc
ds_read_b32 v20, v190 offset:37888
s_waitcnt lgkmcnt(0)
v_add_u32 v20, v20, v174
v_lshlrev_b32 v20, 3, v20
ds_write_b64 v20, v[144:145] offset:38208
s_mov_b64 exec, s[30:31]
v_cmp_lt_i32 vcc, 3, v18
s_and_saveexec_b64 s[30:31], vcc
ds_read_b32 v20, v191 offset:37888
s_waitcnt lgkmcnt(0)
v_add_u32 v20, v20, v175
v_lshlrev_b32 v20, 3, v20
ds_write_b64 v20, v[146:147] offset:38208
s_mov_b64 exec, s[30:31]
v_cmp_lt_i32 vcc, 4, v18
s_and_saveexec_b64 s[30:31], vcc
ds_read_b32 v20, v192 offset:37888
s_waitcnt lgkmcnt(0)
v_add_u32 v20, v20, v176
v_lshlrev_b32 v20, 3, v20
ds_write_b64 v20, v[148:149] offset:38208
s_mov_b64 exec, s[30:31]
v_cmp_lt_i32 vcc, 5, v18
s_and_saveexec_b64 s[30:31], vcc
ds_read_b32 v20, v193 offset:37888
s_waitcnt lgkmcnt(0)
v_add_u32 v20, v20, v177
v_lshlrev_b32 v20, 3, v20
ds_write_b64 v20, v[150:151] offset:38208
s_mov_b64 exec, s[30:31]
v_cmp_lt_i32 vcc, 6, v18
s_and_saveexec_b64 s[30:31], vcc
ds_read_b32 v20, v194 offset:37888
s_waitcnt lgkmcnt(0)
v_add_u32 v20, v20, v178
v_lshlrev_b32 v20, 3, v20
ds_write_b64 v20, v[152:153] offset:38208
s_mov_b64 exec, s[30:31]
v_cmp_lt_i32 vcc, 7, v18
s_and_saveexec_b64 s[30:31], vcc
ds_read_b32 v20, v195 offset:37888
s_waitcnt lgkmcnt(0)
v_add_u32 v20, v20, v179
v_lshlrev_b32 v20, 3, v20
ds_write_b64 v20, v[154:155] offset:38208
s_mov_b64 exec, s[30:31]
v_cmp_lt_i32 vcc, 8, v18
s_and_saveexec_b64 s[30:31], vcc
ds_read_b32 v20, v196 offset:37888
s_waitcnt lgkmcnt(0)
v_add_u32 v20, v20, v180
v_lshlrev_b32 v20, 3, v20
ds_write_b64 v20, v[156:157] offset:38208
s_mov_b64 exec, s[30:31]
v_cmp_lt_i32 vcc, 9, v18
s_and_saveexec_b64 s[30:31], vcc
ds_read_b32 v20, v197 offset:37888
s_waitcnt lgkmcnt(0)
v_add_u32 v20, v20, v181
v_lshlrev_b32 v20, 3, v20
ds_write_b64 v20, v[158:159] offset:38208
s_mov_b64 exec, s[30:31]
v_cmp_lt_i32 vcc, 10, v18
s_and_saveexec_b64 s[30:31], vcc
ds_read_b32 v20, v198 offset:37888
s_waitcnt lgkmcnt(0)
v_add_u32 v20, v20, v182
v_lshlrev_b32 v20, 3, v20
ds_write_b64 v20, v[160:161] offset:38208
s_mov_b64 exec, s[30:31]
v_cmp_lt_i32 vcc, 11, v18
s_and_saveexec_b64 s[30:31], vcc
ds_read_b32 v20, v199 offset:37888
s_waitcnt lgkmcnt(0)
v_add_u32 v20, v20, v183
v_lshlrev_b32 v20, 3, v20
ds_write_b64 v20, v[162:163] offset:38208
s_mov_b64 exec, s[30:31]
v_cmp_lt_i32 vcc, 12, v18
s_and_saveexec_b64 s[30:31], vcc
ds_read_b32 v20, v200 offset:37888
s_waitcnt lgkmcnt(0)
v_add_u32 v20, v20, v184
v_lshlrev_b32 v20, 3, v20
ds_write_b64 v20, v[164:165] offset:38208
s_mov_b64 exec, s[30:31]
v_cmp_lt_i32 vcc, 13, v18
s_and_saveexec_b64 s[30:31], vcc
ds_read_b32 v20, v201 offset:37888
s_waitcnt lgkmcnt(0)
v_add_u32 v20, v20, v185
v_lshlrev_b32 v20, 3, v20
ds_write_b64 v20, v[166:167] offset:38208
s_mov_b64 exec, s[30:31]
v_cmp_lt_i32 vcc, 14, v18
s_and_saveexec_b64 s[30:31], vcc
ds_read_b32 v20, v202 offset:37888
s_waitcnt lgkmcnt(0)
v_add_u32 v20, v20, v186
v_lshlrev_b32 v20, 3, v20
ds_write_b64 v20, v[168:169] offset:38208
s_mov_b64 exec, s[30:31]
v_cmp_lt_i32 vcc, 15, v18
s_and_saveexec_b64 s[30:31], vcc
ds_read_b32 v20, v203 offset:37888
s_waitcnt lgkmcnt(0)
v_add_u32 v20, v20, v187
v_lshlrev_b32 v20, 3, v20
ds_write_b64 v20, v[170:171] offset:38208
s_mov_b64 exec, s[30:31]
v_mov_b32 v30, 38144
ds_read_b32 v29, v30 offset:4
s_waitcnt lgkmcnt(0)
s_barrier
v_readfirstlane_b32 s41, v29
s_add_u32 s41, s41, 31
s_lshr_b32 s41, s41, 5
s_add_u32 s44, s41, 3
s_lshr_b32 s44, s44, 2
s_mul_i32 s42, s28, s44
s_add_u32 s44, s42, s44
s_min_u32 s41, s41, s44
s_mov_b32 s50, -1
s_mov_b32 s52, -1
s_mov_b32 s53, 0
v_mov_b32 v53, 0
v_mov_b32 v54, 0
v_mov_b32 v55, 0
s_mov_b32 s33, 0xbfb8aa3b
s_cmp_ge_u32 s42, s41
s_cbranch_scc1 M_TDONE
s_sub_u32 s45, s41, 1
s_min_u32 s45, s45, s42
s_lshl_b32 s43, s45, 8
v_lshlrev_b32 v20, 1, v2
v_add_u32 v20, s43, v20
ds_read_b64 v[22:23], v20 offset:38208
v_lshl_add_u32 v21, v3, 5, s43
v_add_u32 v21, 38208, v21
ds_read2_b32 v[228:229], v21 offset0:0 offset1:16
ds_read2_b32 v[230:231], v21 offset0:32 offset1:48
s_waitcnt lgkmcnt(0)
v_lshlrev_b32 v24, 7, v23
v_lshl_add_u32 v24, v3, 6, v24
buffer_load_dwordx4 v[204:207], v24, s[12:15], 0 offen offset:0
buffer_load_dwordx4 v[208:211], v24, s[12:15], 0 offen offset:16
buffer_load_dwordx4 v[212:215], v24, s[12:15], 0 offen offset:32
buffer_load_dwordx4 v[216:219], v24, s[12:15], 0 offen offset:48
v_and_b32 v25, 0xfffff, v22
v_lshlrev_b32 v25, 5, v25
v_lshl_add_u32 v25, v3, 4, v25
buffer_load_dwordx4 v[220:223], v25, s[16:19], 0 offen
v_cmp_gt_i32 vcc, 0, v22
v_mov_b32 v26, 0x3f80
v_cndmask_b32 v224, 0, v26, vcc
v_cmp_eq_u32 vcc, 0, v3
v_cndmask_b32 v224, 0, v224, vcc
M_TILE:
s_add_u32 s46, s42, 1
s_sub_u32 s45, s41, 1
s_min_u32 s45, s45, s46
s_lshl_b32 s43, s45, 8
v_lshlrev_b32 v20, 1, v2
v_add_u32 v20, s43, v20
ds_read_b64 v[22:23], v20 offset:38208
v_lshl_add_u32 v21, v3, 5, s43
v_add_u32 v21, 38208, v21
ds_read2_b32 v[56:57], v21 offset0:0 offset1:16
ds_read2_b32 v[58:59], v21 offset0:32 offset1:48
s_waitcnt lgkmcnt(0)
v_lshlrev_b32 v24, 7, v23
v_lshl_add_u32 v24, v3, 6, v24
buffer_load_dwordx4 v[32:35], v24, s[12:15], 0 offen offset:0
buffer_load_dwordx4 v[36:39], v24, s[12:15], 0 offen offset:16
buffer_load_dwordx4 v[40:43], v24, s[12:15], 0 offen offset:32
buffer_load_dwordx4 v[44:47], v24, s[12:15], 0 offen offset:48
v_and_b32 v25, 0xfffff, v22
v_lshlrev_b32 v25, 5, v25
v_lshl_add_u32 v25, v3, 4, v25
buffer_load_dwordx4 v[48:51], v25, s[16:19], 0 offen
v_cmp_gt_i32 vcc, 0, v22
v_mov_b32 v26, 0x3f80
v_cndmask_b32 v52, 0, v26, vcc
v_cmp_eq_u32 vcc, 0, v3
v_cndmask_b32 v52, 0, v52, vcc
v_bfe_u32 v28, v228, 20, 6
v_mul_u32_u24 v27, 768, v28
v_add_u32 v27, v27, v2
ds_read2_b32 v[232:233], v27 offset0:128 offset1:160
v_bfe_u32 v29, v229, 20, 6
v_mul_u32_u24 v27, 768, v29
v_add_u32 v27, v27, v2
ds_read2_b32 v[234:235], v27 offset0:128 offset1:160
v_bfe_u32 v30, v230, 20, 6
v_mul_u32_u24 v27, 768, v30
v_add_u32 v27, v27, v2
ds_read2_b32 v[236:237], v27 offset0:128 offset1:160
v_bfe_u32 v31, v231, 20, 6
v_mul_u32_u24 v27, 768, v31
v_add_u32 v27, v27, v2
ds_read2_b32 v[238:239], v27 offset0:128 offset1:160
s_waitcnt vmcnt(5)
v_mfma_f32_32x32x16_bf16 v[140:155], v[204:207], v[64:67], 0
v_mfma_f32_32x32x16_bf16 v[140:155], v[208:211], v[68:71], v[140:155]
v_mfma_f32_32x32x16_bf16 v[140:155], v[212:215], v[72:75], v[140:155]
v_mfma_f32_32x32x16_bf16 v[140:155], v[216:219], v[76:79], v[140:155]
v_mfma_f32_32x32x16_bf16 v[140:155], v[220:223], v[128:131], v[140:155]
v_mfma_f32_32x32x16_bf16 v[140:155], v[224:227], v[136:139], v[140:155]
v_mfma_f32_32x32x16_bf16 v[172:187], v[204:207], v[96:99], 0
v_mfma_f32_32x32x16_bf16 v[172:187], v[208:211], v[100:103], v[172:187]
v_mfma_f32_32x32x16_bf16 v[172:187], v[212:215], v[104:107], v[172:187]
v_mfma_f32_32x32x16_bf16 v[172:187], v[216:219], v[108:111], v[172:187]
v_mfma_f32_32x32x16_bf16 v[156:171], v[204:207], v[80:83], 0
v_mfma_f32_32x32x16_bf16 v[156:171], v[208:211], v[84:87], v[156:171]
v_mfma_f32_32x32x16_bf16 v[156:171], v[212:215], v[88:91], v[156:171]
v_mfma_f32_32x32x16_bf16 v[156:171], v[216:219], v[92:95], v[156:171]
v_mfma_f32_32x32x16_bf16 v[156:171], v[220:223], v[132:135], v[156:171]
v_mfma_f32_32x32x16_bf16 v[156:171], v[224:227], v[136:139], v[156:171]
v_mfma_f32_32x32x16_bf16 v[188:203], v[204:207], v[112:115], 0
v_mfma_f32_32x32x16_bf16 v[188:203], v[208:211], v[116:119], v[188:203]
v_mfma_f32_32x32x16_bf16 v[188:203], v[212:215], v[120:123], v[188:203]
v_mfma_f32_32x32x16_bf16 v[188:203], v[216:219], v[124:127], v[188:203]
s_waitcnt lgkmcnt(0)
s_nop 15
s_nop 3
v_readfirstlane_b32 s51, v28
s_cmp_eq_u32 s51, s50
s_cbranch_scc1 M_Ka0
s_cmp_lt_i32 s50, 0
s_cbranch_scc1 M_Na0
s_cmp_eq_u32 s53, 0
s_cbranch_scc1 M_Aa0
v_mov_b32 v248, s50
v_mul_u32_u24 v248, 768, v248
v_add_u32 v248, v248, v2
v_xor_b32 v249, 32, v1
v_lshlrev_b32 v249, 2, v249
ds_bpermute_b32 v250, v249, v244
ds_bpermute_b32 v251, v249, v245
ds_bpermute_b32 v252, v249, v246
ds_bpermute_b32 v253, v249, v247
ds_read2_b32 v[254:255], v248 offset0:0 offset1:32
s_waitcnt lgkmcnt(0)
v_add_f32 v244, v244, v250
v_add_f32 v244, v244, v254
v_add_f32 v245, v245, v251
v_add_f32 v245, v245, v255
ds_read2_b32 v[254:255], v248 offset0:64 offset1:96
s_waitcnt lgkmcnt(0)
v_add_f32 v246, v246, v252
v_add_f32 v246, v246, v254
v_add_f32 v247, v247, v253
v_add_f32 v247, v247, v255
ds_write2_b32 v248, v244, v245 offset0:0 offset1:32
ds_write2_b32 v248, v246, v247 offset0:64 offset1:96
s_branch M_Na0
M_Aa0:
v_mov_b32 v248, s50
v_mul_u32_u24 v248, 768, v248
v_add_u32 v248, v248, v2
ds_add_f32 v248, v244
ds_add_f32 v248, v245 offset:128
ds_add_f32 v248, v246 offset:256
ds_add_f32 v248, v247 offset:384
s_mov_b32 s53, 1
M_Na0:
s_mov_b32 s50, s51
v_mov_b32 v244, 0
v_mov_b32 v245, 0
v_mov_b32 v246, 0
v_mov_b32 v247, 0
M_Ka0:
v_fma_f32 v240, v140, s33, v232
v_fma_f32 v241, v141, s33, v232
v_fma_f32 v242, v142, s33, v232
v_fma_f32 v243, v143, s33, v232
v_exp_f32 v240, v240
v_exp_f32 v241, v241
v_exp_f32 v242, v242
v_exp_f32 v243, v243
v_add_f32 v240, 1.0, v240
v_add_f32 v241, 1.0, v241
v_add_f32 v242, 1.0, v242
v_add_f32 v243, 1.0, v243
v_rcp_f32 v240, v240
v_rcp_f32 v241, v241
v_rcp_f32 v242, v242
v_rcp_f32 v243, v243
v_add_f32 v246, v246, v240
v_add_f32 v246, v246, v241
v_add_f32 v246, v246, v242
v_add_f32 v246, v246, v243
v_fmac_f32 v244, v240, v172
v_fmac_f32 v244, v241, v173
v_fmac_f32 v244, v242, v174
v_fmac_f32 v244, v243, v175
v_fma_f32 v240, v156, s33, v233
v_fma_f32 v241, v157, s33, v233
v_fma_f32 v242, v158, s33, v233
v_fma_f32 v243, v159, s33, v233
v_exp_f32 v240, v240
v_exp_f32 v241, v241
v_exp_f32 v242, v242
v_exp_f32 v243, v243
v_add_f32 v240, 1.0, v240
v_add_f32 v241, 1.0, v241
v_add_f32 v242, 1.0, v242
v_add_f32 v243, 1.0, v243
v_rcp_f32 v240, v240
v_rcp_f32 v241, v241
v_rcp_f32 v242, v242
v_rcp_f32 v243, v243
v_add_f32 v247, v247, v240
v_add_f32 v247, v247, v241
v_add_f32 v247, v247, v242
v_add_f32 v247, v247, v243
v_fmac_f32 v245, v240, v188
v_fmac_f32 v245, v241, v189
v_fmac_f32 v245, v242, v190
v_fmac_f32 v245, v243, v191
v_readfirstlane_b32 s51, v29
s_cmp_eq_u32 s51, s50
s_cbranch_scc1 M_Ka1
s_cmp_lt_i32 s50, 0
s_cbranch_scc1 M_Na1
s_cmp_eq_u32 s53, 0
s_cbranch_scc1 M_Aa1
v_mov_b32 v248, s50
v_mul_u32_u24 v248, 768, v248
v_add_u32 v248, v248, v2
v_xor_b32 v249, 32, v1
v_lshlrev_b32 v249, 2, v249
ds_bpermute_b32 v250, v249, v244
ds_bpermute_b32 v251, v249, v245
ds_bpermute_b32 v252, v249, v246
ds_bpermute_b32 v253, v249, v247
ds_read2_b32 v[254:255], v248 offset0:0 offset1:32
s_waitcnt lgkmcnt(0)
v_add_f32 v244, v244, v250
v_add_f32 v244, v244, v254
v_add_f32 v245, v245, v251
v_add_f32 v245, v245, v255
ds_read2_b32 v[254:255], v248 offset0:64 offset1:96
s_waitcnt lgkmcnt(0)
v_add_f32 v246, v246, v252
v_add_f32 v246, v246, v254
v_add_f32 v247, v247, v253
v_add_f32 v247, v247, v255
ds_write2_b32 v248, v244, v245 offset0:0 offset1:32
ds_write2_b32 v248, v246, v247 offset0:64 offset1:96
s_branch M_Na1
M_Aa1:
v_mov_b32 v248, s50
v_mul_u32_u24 v248, 768, v248
v_add_u32 v248, v248, v2
ds_add_f32 v248, v244
ds_add_f32 v248, v245 offset:128
ds_add_f32 v248, v246 offset:256
ds_add_f32 v248, v247 offset:384
s_mov_b32 s53, 1
M_Na1:
s_mov_b32 s50, s51
v_mov_b32 v244, 0
v_mov_b32 v245, 0
v_mov_b32 v246, 0
v_mov_b32 v247, 0
M_Ka1:
v_fma_f32 v240, v144, s33, v234
v_fma_f32 v241, v145, s33, v234
v_fma_f32 v242, v146, s33, v234
v_fma_f32 v243, v147, s33, v234
v_exp_f32 v240, v240
v_exp_f32 v241, v241
v_exp_f32 v242, v242
v_exp_f32 v243, v243
v_add_f32 v240, 1.0, v240
v_add_f32 v241, 1.0, v241
v_add_f32 v242, 1.0, v242
v_add_f32 v243, 1.0, v243
v_rcp_f32 v240, v240
v_rcp_f32 v241, v241
v_rcp_f32 v242, v242
v_rcp_f32 v243, v243
v_add_f32 v246, v246, v240
v_add_f32 v246, v246, v241
v_add_f32 v246, v246, v242
v_add_f32 v246, v246, v243
v_fmac_f32 v244, v240, v176
v_fmac_f32 v244, v241, v177
v_fmac_f32 v244, v242, v178
v_fmac_f32 v244, v243, v179
v_fma_f32 v240, v160, s33, v235
v_fma_f32 v241, v161, s33, v235
v_fma_f32 v242, v162, s33, v235
v_fma_f32 v243, v163, s33, v235
v_exp_f32 v240, v240
v_exp_f32 v241, v241
v_exp_f32 v242, v242
v_exp_f32 v243, v243
v_add_f32 v240, 1.0, v240
v_add_f32 v241, 1.0, v241
v_add_f32 v242, 1.0, v242
v_add_f32 v243, 1.0, v243
v_rcp_f32 v240, v240
v_rcp_f32 v241, v241
v_rcp_f32 v242, v242
v_rcp_f32 v243, v243
v_add_f32 v247, v247, v240
v_add_f32 v247, v247, v241
v_add_f32 v247, v247, v242
v_add_f32 v247, v247, v243
v_fmac_f32 v245, v240, v192
v_fmac_f32 v245, v241, v193
v_fmac_f32 v245, v242, v194
v_fmac_f32 v245, v243, v195
v_readfirstlane_b32 s51, v30
s_cmp_eq_u32 s51, s50
s_cbranch_scc1 M_Ka2
s_cmp_lt_i32 s50, 0
s_cbranch_scc1 M_Na2
s_cmp_eq_u32 s53, 0
s_cbranch_scc1 M_Aa2
v_mov_b32 v248, s50
v_mul_u32_u24 v248, 768, v248
v_add_u32 v248, v248, v2
v_xor_b32 v249, 32, v1
v_lshlrev_b32 v249, 2, v249
ds_bpermute_b32 v250, v249, v244
ds_bpermute_b32 v251, v249, v245
ds_bpermute_b32 v252, v249, v246
ds_bpermute_b32 v253, v249, v247
ds_read2_b32 v[254:255], v248 offset0:0 offset1:32
s_waitcnt lgkmcnt(0)
v_add_f32 v244, v244, v250
v_add_f32 v244, v244, v254
v_add_f32 v245, v245, v251
v_add_f32 v245, v245, v255
ds_read2_b32 v[254:255], v248 offset0:64 offset1:96
s_waitcnt lgkmcnt(0)
v_add_f32 v246, v246, v252
v_add_f32 v246, v246, v254
v_add_f32 v247, v247, v253
v_add_f32 v247, v247, v255
ds_write2_b32 v248, v244, v245 offset0:0 offset1:32
ds_write2_b32 v248, v246, v247 offset0:64 offset1:96
s_branch M_Na2
M_Aa2:
v_mov_b32 v248, s50
v_mul_u32_u24 v248, 768, v248
v_add_u32 v248, v248, v2
ds_add_f32 v248, v244
ds_add_f32 v248, v245 offset:128
ds_add_f32 v248, v246 offset:256
ds_add_f32 v248, v247 offset:384
s_mov_b32 s53, 1
M_Na2:
s_mov_b32 s50, s51
v_mov_b32 v244, 0
v_mov_b32 v245, 0
v_mov_b32 v246, 0
v_mov_b32 v247, 0
M_Ka2:
v_fma_f32 v240, v148, s33, v236
v_fma_f32 v241, v149, s33, v236
v_fma_f32 v242, v150, s33, v236
v_fma_f32 v243, v151, s33, v236
v_exp_f32 v240, v240
v_exp_f32 v241, v241
v_exp_f32 v242, v242
v_exp_f32 v243, v243
v_add_f32 v240, 1.0, v240
v_add_f32 v241, 1.0, v241
v_add_f32 v242, 1.0, v242
v_add_f32 v243, 1.0, v243
v_rcp_f32 v240, v240
v_rcp_f32 v241, v241
v_rcp_f32 v242, v242
v_rcp_f32 v243, v243
v_add_f32 v246, v246, v240
v_add_f32 v246, v246, v241
v_add_f32 v246, v246, v242
v_add_f32 v246, v246, v243
v_fmac_f32 v244, v240, v180
v_fmac_f32 v244, v241, v181
v_fmac_f32 v244, v242, v182
v_fmac_f32 v244, v243, v183
v_fma_f32 v240, v164, s33, v237
v_fma_f32 v241, v165, s33, v237
v_fma_f32 v242, v166, s33, v237
v_fma_f32 v243, v167, s33, v237
v_exp_f32 v240, v240
v_exp_f32 v241, v241
v_exp_f32 v242, v242
v_exp_f32 v243, v243
v_add_f32 v240, 1.0, v240
v_add_f32 v241, 1.0, v241
v_add_f32 v242, 1.0, v242
v_add_f32 v243, 1.0, v243
v_rcp_f32 v240, v240
v_rcp_f32 v241, v241
v_rcp_f32 v242, v242
v_rcp_f32 v243, v243
v_add_f32 v247, v247, v240
v_add_f32 v247, v247, v241
v_add_f32 v247, v247, v242
v_add_f32 v247, v247, v243
v_fmac_f32 v245, v240, v196
v_fmac_f32 v245, v241, v197
v_fmac_f32 v245, v242, v198
v_fmac_f32 v245, v243, v199
v_readfirstlane_b32 s51, v31
s_cmp_eq_u32 s51, s50
s_cbranch_scc1 M_Ka3
s_cmp_lt_i32 s50, 0
s_cbranch_scc1 M_Na3
s_cmp_eq_u32 s53, 0
s_cbranch_scc1 M_Aa3
v_mov_b32 v248, s50
v_mul_u32_u24 v248, 768, v248
v_add_u32 v248, v248, v2
v_xor_b32 v249, 32, v1
v_lshlrev_b32 v249, 2, v249
ds_bpermute_b32 v250, v249, v244
ds_bpermute_b32 v251, v249, v245
ds_bpermute_b32 v252, v249, v246
ds_bpermute_b32 v253, v249, v247
ds_read2_b32 v[254:255], v248 offset0:0 offset1:32
s_waitcnt lgkmcnt(0)
v_add_f32 v244, v244, v250
v_add_f32 v244, v244, v254
v_add_f32 v245, v245, v251
v_add_f32 v245, v245, v255
ds_read2_b32 v[254:255], v248 offset0:64 offset1:96
s_waitcnt lgkmcnt(0)
v_add_f32 v246, v246, v252
v_add_f32 v246, v246, v254
v_add_f32 v247, v247, v253
v_add_f32 v247, v247, v255
ds_write2_b32 v248, v244, v245 offset0:0 offset1:32
ds_write2_b32 v248, v246, v247 offset0:64 offset1:96
s_branch M_Na3
M_Aa3:
v_mov_b32 v248, s50
v_mul_u32_u24 v248, 768, v248
v_add_u32 v248, v248, v2
ds_add_f32 v248, v244
ds_add_f32 v248, v245 offset:128
ds_add_f32 v248, v246 offset:256
ds_add_f32 v248, v247 offset:384
s_mov_b32 s53, 1
M_Na3:
s_mov_b32 s50, s51
v_mov_b32 v244, 0
v_mov_b32 v245, 0
v_mov_b32 v246, 0
v_mov_b32 v247, 0
M_Ka3:
v_fma_f32 v240, v152, s33, v238
v_fma_f32 v241, v153, s33, v238
v_fma_f32 v242, v154, s33, v238
v_fma_f32 v243, v155, s33, v238
v_exp_f32 v240, v240
v_exp_f32 v241, v241
v_exp_f32 v242, v242
v_exp_f32 v243, v243
v_add_f32 v240, 1.0, v240
v_add_f32 v241, 1.0, v241
v_add_f32 v242, 1.0, v242
v_add_f32 v243, 1.0, v243
v_rcp_f32 v240, v240
v_rcp_f32 v241, v241
v_rcp_f32 v242, v242
v_rcp_f32 v243, v243
v_add_f32 v246, v246, v240
v_add_f32 v246, v246, v241
v_add_f32 v246, v246, v242
v_add_f32 v246, v246, v243
v_fmac_f32 v244, v240, v184
v_fmac_f32 v244, v241, v185
v_fmac_f32 v244, v242, v186
v_fmac_f32 v244, v243, v187
v_fma_f32 v240, v168, s33, v239
v_fma_f32 v241, v169, s33, v239
v_fma_f32 v242, v170, s33, v239
v_fma_f32 v243, v171, s33, v239
v_exp_f32 v240, v240
v_exp_f32 v241, v241
v_exp_f32 v242, v242
v_exp_f32 v243, v243
v_add_f32 v240, 1.0, v240
v_add_f32 v241, 1.0, v241
v_add_f32 v242, 1.0, v242
v_add_f32 v243, 1.0, v243
v_rcp_f32 v240, v240
v_rcp_f32 v241, v241
v_rcp_f32 v242, v242
v_rcp_f32 v243, v243
v_add_f32 v247, v247, v240
v_add_f32 v247, v247, v241
v_add_f32 v247, v247, v242
v_add_f32 v247, v247, v243
v_fmac_f32 v245, v240, v200
v_fmac_f32 v245, v241, v201
v_fmac_f32 v245, v242, v202
v_fmac_f32 v245, v243, v203
s_add_u32 s42, s42, 1
s_cmp_ge_u32 s42, s41
s_cbranch_scc1 M_TDONE
s_add_u32 s46, s42, 1
s_sub_u32 s45, s41, 1
s_min_u32 s45, s45, s46
s_lshl_b32 s43, s45, 8
v_lshlrev_b32 v20, 1, v2
v_add_u32 v20, s43, v20
ds_read_b64 v[22:23], v20 offset:38208
v_lshl_add_u32 v21, v3, 5, s43
v_add_u32 v21, 38208, v21
ds_read2_b32 v[228:229], v21 offset0:0 offset1:16
ds_read2_b32 v[230:231], v21 offset0:32 offset1:48
s_waitcnt lgkmcnt(0)
v_lshlrev_b32 v24, 7, v23
v_lshl_add_u32 v24, v3, 6, v24
buffer_load_dwordx4 v[204:207], v24, s[12:15], 0 offen offset:0
buffer_load_dwordx4 v[208:211], v24, s[12:15], 0 offen offset:16
buffer_load_dwordx4 v[212:215], v24, s[12:15], 0 offen offset:32
buffer_load_dwordx4 v[216:219], v24, s[12:15], 0 offen offset:48
v_and_b32 v25, 0xfffff, v22
v_lshlrev_b32 v25, 5, v25
v_lshl_add_u32 v25, v3, 4, v25
buffer_load_dwordx4 v[220:223], v25, s[16:19], 0 offen
v_cmp_gt_i32 vcc, 0, v22
v_mov_b32 v26, 0x3f80
v_cndmask_b32 v224, 0, v26, vcc
v_cmp_eq_u32 vcc, 0, v3
v_cndmask_b32 v224, 0, v224, vcc
v_bfe_u32 v28, v56, 20, 6
v_mul_u32_u24 v27, 768, v28
v_add_u32 v27, v27, v2
ds_read2_b32 v[232:233], v27 offset0:128 offset1:160
v_bfe_u32 v29, v57, 20, 6
v_mul_u32_u24 v27, 768, v29
v_add_u32 v27, v27, v2
ds_read2_b32 v[234:235], v27 offset0:128 offset1:160
v_bfe_u32 v30, v58, 20, 6
v_mul_u32_u24 v27, 768, v30
v_add_u32 v27, v27, v2
ds_read2_b32 v[236:237], v27 offset0:128 offset1:160
v_bfe_u32 v31, v59, 20, 6
v_mul_u32_u24 v27, 768, v31
v_add_u32 v27, v27, v2
ds_read2_b32 v[238:239], v27 offset0:128 offset1:160
s_waitcnt vmcnt(5)
v_mfma_f32_32x32x16_bf16 v[140:155], v[32:35], v[64:67], 0
v_mfma_f32_32x32x16_bf16 v[140:155], v[36:39], v[68:71], v[140:155]
v_mfma_f32_32x32x16_bf16 v[140:155], v[40:43], v[72:75], v[140:155]
v_mfma_f32_32x32x16_bf16 v[140:155], v[44:47], v[76:79], v[140:155]
v_mfma_f32_32x32x16_bf16 v[140:155], v[48:51], v[128:131], v[140:155]
v_mfma_f32_32x32x16_bf16 v[140:155], v[52:55], v[136:139], v[140:155]
v_mfma_f32_32x32x16_bf16 v[172:187], v[32:35], v[96:99], 0
v_mfma_f32_32x32x16_bf16 v[172:187], v[36:39], v[100:103], v[172:187]
v_mfma_f32_32x32x16_bf16 v[172:187], v[40:43], v[104:107], v[172:187]
v_mfma_f32_32x32x16_bf16 v[172:187], v[44:47], v[108:111], v[172:187]
v_mfma_f32_32x32x16_bf16 v[156:171], v[32:35], v[80:83], 0
v_mfma_f32_32x32x16_bf16 v[156:171], v[36:39], v[84:87], v[156:171]
v_mfma_f32_32x32x16_bf16 v[156:171], v[40:43], v[88:91], v[156:171]
v_mfma_f32_32x32x16_bf16 v[156:171], v[44:47], v[92:95], v[156:171]
v_mfma_f32_32x32x16_bf16 v[156:171], v[48:51], v[132:135], v[156:171]
v_mfma_f32_32x32x16_bf16 v[156:171], v[52:55], v[136:139], v[156:171]
v_mfma_f32_32x32x16_bf16 v[188:203], v[32:35], v[112:115], 0
v_mfma_f32_32x32x16_bf16 v[188:203], v[36:39], v[116:119], v[188:203]
v_mfma_f32_32x32x16_bf16 v[188:203], v[40:43], v[120:123], v[188:203]
v_mfma_f32_32x32x16_bf16 v[188:203], v[44:47], v[124:127], v[188:203]
s_waitcnt lgkmcnt(0)
s_nop 15
s_nop 3
v_readfirstlane_b32 s51, v28
s_cmp_eq_u32 s51, s50
s_cbranch_scc1 M_Kb0
s_cmp_lt_i32 s50, 0
s_cbranch_scc1 M_Nb0
s_cmp_eq_u32 s53, 0
s_cbranch_scc1 M_Ab0
v_mov_b32 v248, s50
v_mul_u32_u24 v248, 768, v248
v_add_u32 v248, v248, v2
v_xor_b32 v249, 32, v1
v_lshlrev_b32 v249, 2, v249
ds_bpermute_b32 v250, v249, v244
ds_bpermute_b32 v251, v249, v245
ds_bpermute_b32 v252, v249, v246
ds_bpermute_b32 v253, v249, v247
ds_read2_b32 v[254:255], v248 offset0:0 offset1:32
s_waitcnt lgkmcnt(0)
v_add_f32 v244, v244, v250
v_add_f32 v244, v244, v254
v_add_f32 v245, v245, v251
v_add_f32 v245, v245, v255
ds_read2_b32 v[254:255], v248 offset0:64 offset1:96
s_waitcnt lgkmcnt(0)
v_add_f32 v246, v246, v252
v_add_f32 v246, v246, v254
v_add_f32 v247, v247, v253
v_add_f32 v247, v247, v255
ds_write2_b32 v248, v244, v245 offset0:0 offset1:32
ds_write2_b32 v248, v246, v247 offset0:64 offset1:96
s_branch M_Nb0
M_Ab0:
v_mov_b32 v248, s50
v_mul_u32_u24 v248, 768, v248
v_add_u32 v248, v248, v2
ds_add_f32 v248, v244
ds_add_f32 v248, v245 offset:128
ds_add_f32 v248, v246 offset:256
ds_add_f32 v248, v247 offset:384
s_mov_b32 s53, 1
M_Nb0:
s_mov_b32 s50, s51
v_mov_b32 v244, 0
v_mov_b32 v245, 0
v_mov_b32 v246, 0
v_mov_b32 v247, 0
M_Kb0:
v_fma_f32 v240, v140, s33, v232
v_fma_f32 v241, v141, s33, v232
v_fma_f32 v242, v142, s33, v232
v_fma_f32 v243, v143, s33, v232
v_exp_f32 v240, v240
v_exp_f32 v241, v241
v_exp_f32 v242, v242
v_exp_f32 v243, v243
v_add_f32 v240, 1.0, v240
v_add_f32 v241, 1.0, v241
v_add_f32 v242, 1.0, v242
v_add_f32 v243, 1.0, v243
v_rcp_f32 v240, v240
v_rcp_f32 v241, v241
v_rcp_f32 v242, v242
v_rcp_f32 v243, v243
v_add_f32 v246, v246, v240
v_add_f32 v246, v246, v241
v_add_f32 v246, v246, v242
v_add_f32 v246, v246, v243
v_fmac_f32 v244, v240, v172
v_fmac_f32 v244, v241, v173
v_fmac_f32 v244, v242, v174
v_fmac_f32 v244, v243, v175
v_fma_f32 v240, v156, s33, v233
v_fma_f32 v241, v157, s33, v233
v_fma_f32 v242, v158, s33, v233
v_fma_f32 v243, v159, s33, v233
v_exp_f32 v240, v240
v_exp_f32 v241, v241
v_exp_f32 v242, v242
v_exp_f32 v243, v243
v_add_f32 v240, 1.0, v240
v_add_f32 v241, 1.0, v241
v_add_f32 v242, 1.0, v242
v_add_f32 v243, 1.0, v243
v_rcp_f32 v240, v240
v_rcp_f32 v241, v241
v_rcp_f32 v242, v242
v_rcp_f32 v243, v243
v_add_f32 v247, v247, v240
v_add_f32 v247, v247, v241
v_add_f32 v247, v247, v242
v_add_f32 v247, v247, v243
v_fmac_f32 v245, v240, v188
v_fmac_f32 v245, v241, v189
v_fmac_f32 v245, v242, v190
v_fmac_f32 v245, v243, v191
v_readfirstlane_b32 s51, v29
s_cmp_eq_u32 s51, s50
s_cbranch_scc1 M_Kb1
s_cmp_lt_i32 s50, 0
s_cbranch_scc1 M_Nb1
s_cmp_eq_u32 s53, 0
s_cbranch_scc1 M_Ab1
v_mov_b32 v248, s50
v_mul_u32_u24 v248, 768, v248
v_add_u32 v248, v248, v2
v_xor_b32 v249, 32, v1
v_lshlrev_b32 v249, 2, v249
ds_bpermute_b32 v250, v249, v244
ds_bpermute_b32 v251, v249, v245
ds_bpermute_b32 v252, v249, v246
ds_bpermute_b32 v253, v249, v247
ds_read2_b32 v[254:255], v248 offset0:0 offset1:32
s_waitcnt lgkmcnt(0)
v_add_f32 v244, v244, v250
v_add_f32 v244, v244, v254
v_add_f32 v245, v245, v251
v_add_f32 v245, v245, v255
ds_read2_b32 v[254:255], v248 offset0:64 offset1:96
s_waitcnt lgkmcnt(0)
v_add_f32 v246, v246, v252
v_add_f32 v246, v246, v254
v_add_f32 v247, v247, v253
v_add_f32 v247, v247, v255
ds_write2_b32 v248, v244, v245 offset0:0 offset1:32
ds_write2_b32 v248, v246, v247 offset0:64 offset1:96
s_branch M_Nb1
M_Ab1:
v_mov_b32 v248, s50
v_mul_u32_u24 v248, 768, v248
v_add_u32 v248, v248, v2
ds_add_f32 v248, v244
ds_add_f32 v248, v245 offset:128
ds_add_f32 v248, v246 offset:256
ds_add_f32 v248, v247 offset:384
s_mov_b32 s53, 1
M_Nb1:
s_mov_b32 s50, s51
v_mov_b32 v244, 0
v_mov_b32 v245, 0
v_mov_b32 v246, 0
v_mov_b32 v247, 0
M_Kb1:
v_fma_f32 v240, v144, s33, v234
v_fma_f32 v241, v145, s33, v234
v_fma_f32 v242, v146, s33, v234
v_fma_f32 v243, v147, s33, v234
v_exp_f32 v240, v240
v_exp_f32 v241, v241
v_exp_f32 v242, v242
v_exp_f32 v243, v243
v_add_f32 v240, 1.0, v240
v_add_f32 v241, 1.0, v241
v_add_f32 v242, 1.0, v242
v_add_f32 v243, 1.0, v243
v_rcp_f32 v240, v240
v_rcp_f32 v241, v241
v_rcp_f32 v242, v242
v_rcp_f32 v243, v243
v_add_f32 v246, v246, v240
v_add_f32 v246, v246, v241
v_add_f32 v246, v246, v242
v_add_f32 v246, v246, v243
v_fmac_f32 v244, v240, v176
v_fmac_f32 v244, v241, v177
v_fmac_f32 v244, v242, v178
v_fmac_f32 v244, v243, v179
v_fma_f32 v240, v160, s33, v235
v_fma_f32 v241, v161, s33, v235
v_fma_f32 v242, v162, s33, v235
v_fma_f32 v243, v163, s33, v235
v_exp_f32 v240, v240
v_exp_f32 v241, v241
v_exp_f32 v242, v242
v_exp_f32 v243, v243
v_add_f32 v240, 1.0, v240
v_add_f32 v241, 1.0, v241
v_add_f32 v242, 1.0, v242
v_add_f32 v243, 1.0, v243
v_rcp_f32 v240, v240
v_rcp_f32 v241, v241
v_rcp_f32 v242, v242
v_rcp_f32 v243, v243
v_add_f32 v247, v247, v240
v_add_f32 v247, v247, v241
v_add_f32 v247, v247, v242
v_add_f32 v247, v247, v243
v_fmac_f32 v245, v240, v192
v_fmac_f32 v245, v241, v193
v_fmac_f32 v245, v242, v194
v_fmac_f32 v245, v243, v195
v_readfirstlane_b32 s51, v30
s_cmp_eq_u32 s51, s50
s_cbranch_scc1 M_Kb2
s_cmp_lt_i32 s50, 0
s_cbranch_scc1 M_Nb2
s_cmp_eq_u32 s53, 0
s_cbranch_scc1 M_Ab2
v_mov_b32 v248, s50
v_mul_u32_u24 v248, 768, v248
v_add_u32 v248, v248, v2
v_xor_b32 v249, 32, v1
v_lshlrev_b32 v249, 2, v249
ds_bpermute_b32 v250, v249, v244
ds_bpermute_b32 v251, v249, v245
ds_bpermute_b32 v252, v249, v246
ds_bpermute_b32 v253, v249, v247
ds_read2_b32 v[254:255], v248 offset0:0 offset1:32
s_waitcnt lgkmcnt(0)
v_add_f32 v244, v244, v250
v_add_f32 v244, v244, v254
v_add_f32 v245, v245, v251
v_add_f32 v245, v245, v255
ds_read2_b32 v[254:255], v248 offset0:64 offset1:96
s_waitcnt lgkmcnt(0)
v_add_f32 v246, v246, v252
v_add_f32 v246, v246, v254
v_add_f32 v247, v247, v253
v_add_f32 v247, v247, v255
ds_write2_b32 v248, v244, v245 offset0:0 offset1:32
ds_write2_b32 v248, v246, v247 offset0:64 offset1:96
s_branch M_Nb2
M_Ab2:
v_mov_b32 v248, s50
v_mul_u32_u24 v248, 768, v248
v_add_u32 v248, v248, v2
ds_add_f32 v248, v244
ds_add_f32 v248, v245 offset:128
ds_add_f32 v248, v246 offset:256
ds_add_f32 v248, v247 offset:384
s_mov_b32 s53, 1
M_Nb2:
s_mov_b32 s50, s51
v_mov_b32 v244, 0
v_mov_b32 v245, 0
v_mov_b32 v246, 0
v_mov_b32 v247, 0
M_Kb2:
v_fma_f32 v240, v148, s33, v236
v_fma_f32 v241, v149, s33, v236
v_fma_f32 v242, v150, s33, v236
v_fma_f32 v243, v151, s33, v236
v_exp_f32 v240, v240
v_exp_f32 v241, v241
v_exp_f32 v242, v242
v_exp_f32 v243, v243
v_add_f32 v240, 1.0, v240
v_add_f32 v241, 1.0, v241
v_add_f32 v242, 1.0, v242
v_add_f32 v243, 1.0, v243
v_rcp_f32 v240, v240
v_rcp_f32 v241, v241
v_rcp_f32 v242, v242
v_rcp_f32 v243, v243
v_add_f32 v246, v246, v240
v_add_f32 v246, v246, v241
v_add_f32 v246, v246, v242
v_add_f32 v246, v246, v243
v_fmac_f32 v244, v240, v180
v_fmac_f32 v244, v241, v181
v_fmac_f32 v244, v242, v182
v_fmac_f32 v244, v243, v183
v_fma_f32 v240, v164, s33, v237
v_fma_f32 v241, v165, s33, v237
v_fma_f32 v242, v166, s33, v237
v_fma_f32 v243, v167, s33, v237
v_exp_f32 v240, v240
v_exp_f32 v241, v241
v_exp_f32 v242, v242
v_exp_f32 v243, v243
v_add_f32 v240, 1.0, v240
v_add_f32 v241, 1.0, v241
v_add_f32 v242, 1.0, v242
v_add_f32 v243, 1.0, v243
v_rcp_f32 v240, v240
v_rcp_f32 v241, v241
v_rcp_f32 v242, v242
v_rcp_f32 v243, v243
v_add_f32 v247, v247, v240
v_add_f32 v247, v247, v241
v_add_f32 v247, v247, v242
v_add_f32 v247, v247, v243
v_fmac_f32 v245, v240, v196
v_fmac_f32 v245, v241, v197
v_fmac_f32 v245, v242, v198
v_fmac_f32 v245, v243, v199
v_readfirstlane_b32 s51, v31
s_cmp_eq_u32 s51, s50
s_cbranch_scc1 M_Kb3
s_cmp_lt_i32 s50, 0
s_cbranch_scc1 M_Nb3
s_cmp_eq_u32 s53, 0
s_cbranch_scc1 M_Ab3
v_mov_b32 v248, s50
v_mul_u32_u24 v248, 768, v248
v_add_u32 v248, v248, v2
v_xor_b32 v249, 32, v1
v_lshlrev_b32 v249, 2, v249
ds_bpermute_b32 v250, v249, v244
ds_bpermute_b32 v251, v249, v245
ds_bpermute_b32 v252, v249, v246
ds_bpermute_b32 v253, v249, v247
ds_read2_b32 v[254:255], v248 offset0:0 offset1:32
s_waitcnt lgkmcnt(0)
v_add_f32 v244, v244, v250
v_add_f32 v244, v244, v254
v_add_f32 v245, v245, v251
v_add_f32 v245, v245, v255
ds_read2_b32 v[254:255], v248 offset0:64 offset1:96
s_waitcnt lgkmcnt(0)
v_add_f32 v246, v246, v252
v_add_f32 v246, v246, v254
v_add_f32 v247, v247, v253
v_add_f32 v247, v247, v255
ds_write2_b32 v248, v244, v245 offset0:0 offset1:32
ds_write2_b32 v248, v246, v247 offset0:64 offset1:96
s_branch M_Nb3
M_Ab3:
v_mov_b32 v248, s50
v_mul_u32_u24 v248, 768, v248
v_add_u32 v248, v248, v2
ds_add_f32 v248, v244
ds_add_f32 v248, v245 offset:128
ds_add_f32 v248, v246 offset:256
ds_add_f32 v248, v247 offset:384
s_mov_b32 s53, 1
M_Nb3:
s_mov_b32 s50, s51
v_mov_b32 v244, 0
v_mov_b32 v245, 0
v_mov_b32 v246, 0
v_mov_b32 v247, 0
M_Kb3:
v_fma_f32 v240, v152, s33, v238
v_fma_f32 v241, v153, s33, v238
v_fma_f32 v242, v154, s33, v238
v_fma_f32 v243, v155, s33, v238
v_exp_f32 v240, v240
v_exp_f32 v241, v241
v_exp_f32 v242, v242
v_exp_f32 v243, v243
v_add_f32 v240, 1.0, v240
v_add_f32 v241, 1.0, v241
v_add_f32 v242, 1.0, v242
v_add_f32 v243, 1.0, v243
v_rcp_f32 v240, v240
v_rcp_f32 v241, v241
v_rcp_f32 v242, v242
v_rcp_f32 v243, v243
v_add_f32 v246, v246, v240
v_add_f32 v246, v246, v241
v_add_f32 v246, v246, v242
v_add_f32 v246, v246, v243
v_fmac_f32 v244, v240, v184
v_fmac_f32 v244, v241, v185
v_fmac_f32 v244, v242, v186
v_fmac_f32 v244, v243, v187
v_fma_f32 v240, v168, s33, v239
v_fma_f32 v241, v169, s33, v239
v_fma_f32 v242, v170, s33, v239
v_fma_f32 v243, v171, s33, v239
v_exp_f32 v240, v240
v_exp_f32 v241, v241
v_exp_f32 v242, v242
v_exp_f32 v243, v243
v_add_f32 v240, 1.0, v240
v_add_f32 v241, 1.0, v241
v_add_f32 v242, 1.0, v242
v_add_f32 v243, 1.0, v243
v_rcp_f32 v240, v240
v_rcp_f32 v241, v241
v_rcp_f32 v242, v242
v_rcp_f32 v243, v243
v_add_f32 v247, v247, v240
v_add_f32 v247, v247, v241
v_add_f32 v247, v247, v242
v_add_f32 v247, v247, v243
v_fmac_f32 v245, v240, v200
v_fmac_f32 v245, v241, v201
v_fmac_f32 v245, v242, v202
v_fmac_f32 v245, v243, v203
s_add_u32 s42, s42, 1
s_cmp_lt_u32 s42, s41
s_cbranch_scc1 M_TILE
M_TDONE:
s_waitcnt vmcnt(0)
s_cmp_lt_i32 s50, 0
s_cbranch_scc1 M_NF
v_mov_b32 v248, s50
v_mul_u32_u24 v248, 768, v248
v_add_u32 v248, v248, v2
ds_add_f32 v248, v244
ds_add_f32 v248, v245 offset:128
ds_add_f32 v248, v246 offset:256
ds_add_f32 v248, v247 offset:384
M_NF:
v_mov_b32 v240, 0
s_waitcnt lgkmcnt(0)
s_barrier
s_add_u32 s35, s35, 1
s_branch M_BATCH
M_FIN:
s_cmp_ge_u32 s28, 2
s_cbranch_scc1 M_END
s_lshl_b32 s32, s28, 5
v_and_b32 v10, 31, v1
v_add_u32 v10, s32, v10
v_lshlrev_b32 v10, 9, v10
v_add_u32 v10, s2, v10
v_lshlrev_b32 v10, 7, v10
v_lshl_add_u32 v10, v3, 6, v10
buffer_load_dwordx4 v[204:207], v10, s[12:15], 0 offen offset:0
buffer_load_dwordx4 v[208:211], v10, s[12:15], 0 offen offset:16
buffer_load_dwordx4 v[212:215], v10, s[12:15], 0 offen offset:32
buffer_load_dwordx4 v[216:219], v10, s[12:15], 0 offen offset:48
v_lshlrev_b32 v11, 4, v1
v_add_u32 v12, 12607488, v11
buffer_load_dwordx4 v[64:67], v12, s[24:27], 0 offen
v_add_u32 v12, 12608512, v11
buffer_load_dwordx4 v[68:71], v12, s[24:27], 0 offen
v_add_u32 v12, 12609536, v11
buffer_load_dwordx4 v[72:75], v12, s[24:27], 0 offen
v_add_u32 v12, 12610560, v11
buffer_load_dwordx4 v[76:79], v12, s[24:27], 0 offen
v_add_u32 v12, 12611584, v11
buffer_load_dwordx4 v[80:83], v12, s[24:27], 0 offen
v_add_u32 v12, 12612608, v11
buffer_load_dwordx4 v[84:87], v12, s[24:27], 0 offen
v_add_u32 v12, 12613632, v11
buffer_load_dwordx4 v[88:91], v12, s[24:27], 0 offen
v_add_u32 v12, 12614656, v11
buffer_load_dwordx4 v[92:95], v12, s[24:27], 0 offen
s_waitcnt vmcnt(0)
v_mfma_f32_32x32x16_bf16 v[140:155], v[204:207], v[64:67], 0
v_mfma_f32_32x32x16_bf16 v[140:155], v[208:211], v[68:71], v[140:155]
v_mfma_f32_32x32x16_bf16 v[140:155], v[212:215], v[72:75], v[140:155]
v_mfma_f32_32x32x16_bf16 v[140:155], v[216:219], v[76:79], v[140:155]
v_mfma_f32_32x32x16_bf16 v[156:171], v[204:207], v[80:83], 0
v_mfma_f32_32x32x16_bf16 v[156:171], v[208:211], v[84:87], v[156:171]
v_mfma_f32_32x32x16_bf16 v[156:171], v[212:215], v[88:91], v[156:171]
v_mfma_f32_32x32x16_bf16 v[156:171], v[216:219], v[92:95], v[156:171]
s_nop 15
s_nop 3
v_lshl_add_u32 v13, v3, 2, s32
v_lshrrev_b32 v31, 1, v2
v_add_u32 v14, 0, v13
v_lshlrev_b32 v15, 9, v14
v_add_u32 v15, s2, v15
v_lshlrev_b32 v15, 7, v15
v_add_u32 v172, v15, v31
v_mul_u32_u24 v16, 768, v14
v_add_u32 v16, v16, v2
ds_read2_b32 v[64:65], v16 offset0:0 offset1:64
buffer_load_ushort v204, v172, s[12:15], 0 offen offset:0
ds_read2_b32 v[96:97], v16 offset0:32 offset1:96
buffer_load_ushort v220, v172, s[12:15], 0 offen offset:64
v_add_u32 v14, 1, v13
v_lshlrev_b32 v15, 9, v14
v_add_u32 v15, s2, v15
v_lshlrev_b32 v15, 7, v15
v_add_u32 v173, v15, v31
v_mul_u32_u24 v16, 768, v14
v_add_u32 v16, v16, v2
ds_read2_b32 v[66:67], v16 offset0:0 offset1:64
buffer_load_ushort v205, v173, s[12:15], 0 offen offset:0
ds_read2_b32 v[98:99], v16 offset0:32 offset1:96
buffer_load_ushort v221, v173, s[12:15], 0 offen offset:64
v_add_u32 v14, 2, v13
v_lshlrev_b32 v15, 9, v14
v_add_u32 v15, s2, v15
v_lshlrev_b32 v15, 7, v15
v_add_u32 v174, v15, v31
v_mul_u32_u24 v16, 768, v14
v_add_u32 v16, v16, v2
ds_read2_b32 v[68:69], v16 offset0:0 offset1:64
buffer_load_ushort v206, v174, s[12:15], 0 offen offset:0
ds_read2_b32 v[100:101], v16 offset0:32 offset1:96
buffer_load_ushort v222, v174, s[12:15], 0 offen offset:64
v_add_u32 v14, 3, v13
v_lshlrev_b32 v15, 9, v14
v_add_u32 v15, s2, v15
v_lshlrev_b32 v15, 7, v15
v_add_u32 v175, v15, v31
v_mul_u32_u24 v16, 768, v14
v_add_u32 v16, v16, v2
ds_read2_b32 v[70:71], v16 offset0:0 offset1:64
buffer_load_ushort v207, v175, s[12:15], 0 offen offset:0
ds_read2_b32 v[102:103], v16 offset0:32 offset1:96
buffer_load_ushort v223, v175, s[12:15], 0 offen offset:64
v_add_u32 v14, 8, v13
v_lshlrev_b32 v15, 9, v14
v_add_u32 v15, s2, v15
v_lshlrev_b32 v15, 7, v15
v_add_u32 v176, v15, v31
v_mul_u32_u24 v16, 768, v14
v_add_u32 v16, v16, v2
ds_read2_b32 v[72:73], v16 offset0:0 offset1:64
buffer_load_ushort v208, v176, s[12:15], 0 offen offset:0
ds_read2_b32 v[104:105], v16 offset0:32 offset1:96
buffer_load_ushort v224, v176, s[12:15], 0 offen offset:64
v_add_u32 v14, 9, v13
v_lshlrev_b32 v15, 9, v14
v_add_u32 v15, s2, v15
v_lshlrev_b32 v15, 7, v15
v_add_u32 v177, v15, v31
v_mul_u32_u24 v16, 768, v14
v_add_u32 v16, v16, v2
ds_read2_b32 v[74:75], v16 offset0:0 offset1:64
buffer_load_ushort v209, v177, s[12:15], 0 offen offset:0
ds_read2_b32 v[106:107], v16 offset0:32 offset1:96
buffer_load_ushort v225, v177, s[12:15], 0 offen offset:64
v_add_u32 v14, 10, v13
v_lshlrev_b32 v15, 9, v14
v_add_u32 v15, s2, v15
v_lshlrev_b32 v15, 7, v15
v_add_u32 v178, v15, v31
v_mul_u32_u24 v16, 768, v14
v_add_u32 v16, v16, v2
ds_read2_b32 v[76:77], v16 offset0:0 offset1:64
buffer_load_ushort v210, v178, s[12:15], 0 offen offset:0
ds_read2_b32 v[108:109], v16 offset0:32 offset1:96
buffer_load_ushort v226, v178, s[12:15], 0 offen offset:64
v_add_u32 v14, 11, v13
v_lshlrev_b32 v15, 9, v14
v_add_u32 v15, s2, v15
v_lshlrev_b32 v15, 7, v15
v_add_u32 v179, v15, v31
v_mul_u32_u24 v16, 768, v14
v_add_u32 v16, v16, v2
ds_read2_b32 v[78:79], v16 offset0:0 offset1:64
buffer_load_ushort v211, v179, s[12:15], 0 offen offset:0
ds_read2_b32 v[110:111], v16 offset0:32 offset1:96
buffer_load_ushort v227, v179, s[12:15], 0 offen offset:64
v_add_u32 v14, 16, v13
v_lshlrev_b32 v15, 9, v14
v_add_u32 v15, s2, v15
v_lshlrev_b32 v15, 7, v15
v_add_u32 v180, v15, v31
v_mul_u32_u24 v16, 768, v14
v_add_u32 v16, v16, v2
ds_read2_b32 v[80:81], v16 offset0:0 offset1:64
buffer_load_ushort v212, v180, s[12:15], 0 offen offset:0
ds_read2_b32 v[112:113], v16 offset0:32 offset1:96
buffer_load_ushort v228, v180, s[12:15], 0 offen offset:64
v_add_u32 v14, 17, v13
v_lshlrev_b32 v15, 9, v14
v_add_u32 v15, s2, v15
v_lshlrev_b32 v15, 7, v15
v_add_u32 v181, v15, v31
v_mul_u32_u24 v16, 768, v14
v_add_u32 v16, v16, v2
ds_read2_b32 v[82:83], v16 offset0:0 offset1:64
buffer_load_ushort v213, v181, s[12:15], 0 offen offset:0
ds_read2_b32 v[114:115], v16 offset0:32 offset1:96
buffer_load_ushort v229, v181, s[12:15], 0 offen offset:64
v_add_u32 v14, 18, v13
v_lshlrev_b32 v15, 9, v14
v_add_u32 v15, s2, v15
v_lshlrev_b32 v15, 7, v15
v_add_u32 v182, v15, v31
v_mul_u32_u24 v16, 768, v14
v_add_u32 v16, v16, v2
ds_read2_b32 v[84:85], v16 offset0:0 offset1:64
buffer_load_ushort v214, v182, s[12:15], 0 offen offset:0
ds_read2_b32 v[116:117], v16 offset0:32 offset1:96
buffer_load_ushort v230, v182, s[12:15], 0 offen offset:64
v_add_u32 v14, 19, v13
v_lshlrev_b32 v15, 9, v14
v_add_u32 v15, s2, v15
v_lshlrev_b32 v15, 7, v15
v_add_u32 v183, v15, v31
v_mul_u32_u24 v16, 768, v14
v_add_u32 v16, v16, v2
ds_read2_b32 v[86:87], v16 offset0:0 offset1:64
buffer_load_ushort v215, v183, s[12:15], 0 offen offset:0
ds_read2_b32 v[118:119], v16 offset0:32 offset1:96
buffer_load_ushort v231, v183, s[12:15], 0 offen offset:64
v_add_u32 v14, 24, v13
v_lshlrev_b32 v15, 9, v14
v_add_u32 v15, s2, v15
v_lshlrev_b32 v15, 7, v15
v_add_u32 v184, v15, v31
v_mul_u32_u24 v16, 768, v14
v_add_u32 v16, v16, v2
ds_read2_b32 v[88:89], v16 offset0:0 offset1:64
buffer_load_ushort v216, v184, s[12:15], 0 offen offset:0
ds_read2_b32 v[120:121], v16 offset0:32 offset1:96
buffer_load_ushort v232, v184, s[12:15], 0 offen offset:64
v_add_u32 v14, 25, v13
v_lshlrev_b32 v15, 9, v14
v_add_u32 v15, s2, v15
v_lshlrev_b32 v15, 7, v15
v_add_u32 v185, v15, v31
v_mul_u32_u24 v16, 768, v14
v_add_u32 v16, v16, v2
ds_read2_b32 v[90:91], v16 offset0:0 offset1:64
buffer_load_ushort v217, v185, s[12:15], 0 offen offset:0
ds_read2_b32 v[122:123], v16 offset0:32 offset1:96
buffer_load_ushort v233, v185, s[12:15], 0 offen offset:64
v_add_u32 v14, 26, v13
v_lshlrev_b32 v15, 9, v14
v_add_u32 v15, s2, v15
v_lshlrev_b32 v15, 7, v15
v_add_u32 v186, v15, v31
v_mul_u32_u24 v16, 768, v14
v_add_u32 v16, v16, v2
ds_read2_b32 v[92:93], v16 offset0:0 offset1:64
buffer_load_ushort v218, v186, s[12:15], 0 offen offset:0
ds_read2_b32 v[124:125], v16 offset0:32 offset1:96
buffer_load_ushort v234, v186, s[12:15], 0 offen offset:64
v_add_u32 v14, 27, v13
v_lshlrev_b32 v15, 9, v14
v_add_u32 v15, s2, v15
v_lshlrev_b32 v15, 7, v15
v_add_u32 v187, v15, v31
v_mul_u32_u24 v16, 768, v14
v_add_u32 v16, v16, v2
ds_read2_b32 v[94:95], v16 offset0:0 offset1:64
buffer_load_ushort v219, v187, s[12:15], 0 offen offset:0
ds_read2_b32 v[126:127], v16 offset0:32 offset1:96
buffer_load_ushort v235, v187, s[12:15], 0 offen offset:64
s_waitcnt vmcnt(0) lgkmcnt(0)
v_add_f32 v65, 0x358637bd, v65
v_rcp_f32 v65, v65
s_nop 0
v_fma_f32 v18, v64, v65, v140
v_max_f32 v18, 0, v18
v_lshlrev_b32 v204, 16, v204
v_add_f32 v18, v18, v204
v_cvt_pk_bf16_f32 v18, v18, v18
buffer_store_short v18, v172, s[20:23], 0 offen offset:0
v_add_f32 v67, 0x358637bd, v67
v_rcp_f32 v67, v67
s_nop 0
v_fma_f32 v18, v66, v67, v141
v_max_f32 v18, 0, v18
v_lshlrev_b32 v205, 16, v205
v_add_f32 v18, v18, v205
v_cvt_pk_bf16_f32 v18, v18, v18
buffer_store_short v18, v173, s[20:23], 0 offen offset:0
v_add_f32 v69, 0x358637bd, v69
v_rcp_f32 v69, v69
s_nop 0
v_fma_f32 v18, v68, v69, v142
v_max_f32 v18, 0, v18
v_lshlrev_b32 v206, 16, v206
v_add_f32 v18, v18, v206
v_cvt_pk_bf16_f32 v18, v18, v18
buffer_store_short v18, v174, s[20:23], 0 offen offset:0
v_add_f32 v71, 0x358637bd, v71
v_rcp_f32 v71, v71
s_nop 0
v_fma_f32 v18, v70, v71, v143
v_max_f32 v18, 0, v18
v_lshlrev_b32 v207, 16, v207
v_add_f32 v18, v18, v207
v_cvt_pk_bf16_f32 v18, v18, v18
buffer_store_short v18, v175, s[20:23], 0 offen offset:0
v_add_f32 v73, 0x358637bd, v73
v_rcp_f32 v73, v73
s_nop 0
v_fma_f32 v18, v72, v73, v144
v_max_f32 v18, 0, v18
v_lshlrev_b32 v208, 16, v208
v_add_f32 v18, v18, v208
v_cvt_pk_bf16_f32 v18, v18, v18
buffer_store_short v18, v176, s[20:23], 0 offen offset:0
v_add_f32 v75, 0x358637bd, v75
v_rcp_f32 v75, v75
s_nop 0
v_fma_f32 v18, v74, v75, v145
v_max_f32 v18, 0, v18
v_lshlrev_b32 v209, 16, v209
v_add_f32 v18, v18, v209
v_cvt_pk_bf16_f32 v18, v18, v18
buffer_store_short v18, v177, s[20:23], 0 offen offset:0
v_add_f32 v77, 0x358637bd, v77
v_rcp_f32 v77, v77
s_nop 0
v_fma_f32 v18, v76, v77, v146
v_max_f32 v18, 0, v18
v_lshlrev_b32 v210, 16, v210
v_add_f32 v18, v18, v210
v_cvt_pk_bf16_f32 v18, v18, v18
buffer_store_short v18, v178, s[20:23], 0 offen offset:0
v_add_f32 v79, 0x358637bd, v79
v_rcp_f32 v79, v79
s_nop 0
v_fma_f32 v18, v78, v79, v147
v_max_f32 v18, 0, v18
v_lshlrev_b32 v211, 16, v211
v_add_f32 v18, v18, v211
v_cvt_pk_bf16_f32 v18, v18, v18
buffer_store_short v18, v179, s[20:23], 0 offen offset:0
v_add_f32 v81, 0x358637bd, v81
v_rcp_f32 v81, v81
s_nop 0
v_fma_f32 v18, v80, v81, v148
v_max_f32 v18, 0, v18
v_lshlrev_b32 v212, 16, v212
v_add_f32 v18, v18, v212
v_cvt_pk_bf16_f32 v18, v18, v18
buffer_store_short v18, v180, s[20:23], 0 offen offset:0
v_add_f32 v83, 0x358637bd, v83
v_rcp_f32 v83, v83
s_nop 0
v_fma_f32 v18, v82, v83, v149
v_max_f32 v18, 0, v18
v_lshlrev_b32 v213, 16, v213
v_add_f32 v18, v18, v213
v_cvt_pk_bf16_f32 v18, v18, v18
buffer_store_short v18, v181, s[20:23], 0 offen offset:0
v_add_f32 v85, 0x358637bd, v85
v_rcp_f32 v85, v85
s_nop 0
v_fma_f32 v18, v84, v85, v150
v_max_f32 v18, 0, v18
v_lshlrev_b32 v214, 16, v214
v_add_f32 v18, v18, v214
v_cvt_pk_bf16_f32 v18, v18, v18
buffer_store_short v18, v182, s[20:23], 0 offen offset:0
v_add_f32 v87, 0x358637bd, v87
v_rcp_f32 v87, v87
s_nop 0
v_fma_f32 v18, v86, v87, v151
v_max_f32 v18, 0, v18
v_lshlrev_b32 v215, 16, v215
v_add_f32 v18, v18, v215
v_cvt_pk_bf16_f32 v18, v18, v18
buffer_store_short v18, v183, s[20:23], 0 offen offset:0
v_add_f32 v89, 0x358637bd, v89
v_rcp_f32 v89, v89
s_nop 0
v_fma_f32 v18, v88, v89, v152
v_max_f32 v18, 0, v18
v_lshlrev_b32 v216, 16, v216
v_add_f32 v18, v18, v216
v_cvt_pk_bf16_f32 v18, v18, v18
buffer_store_short v18, v184, s[20:23], 0 offen offset:0
v_add_f32 v91, 0x358637bd, v91
v_rcp_f32 v91, v91
s_nop 0
v_fma_f32 v18, v90, v91, v153
v_max_f32 v18, 0, v18
v_lshlrev_b32 v217, 16, v217
v_add_f32 v18, v18, v217
v_cvt_pk_bf16_f32 v18, v18, v18
buffer_store_short v18, v185, s[20:23], 0 offen offset:0
v_add_f32 v93, 0x358637bd, v93
v_rcp_f32 v93, v93
s_nop 0
v_fma_f32 v18, v92, v93, v154
v_max_f32 v18, 0, v18
v_lshlrev_b32 v218, 16, v218
v_add_f32 v18, v18, v218
v_cvt_pk_bf16_f32 v18, v18, v18
buffer_store_short v18, v186, s[20:23], 0 offen offset:0
v_add_f32 v95, 0x358637bd, v95
v_rcp_f32 v95, v95
s_nop 0
v_fma_f32 v18, v94, v95, v155
v_max_f32 v18, 0, v18
v_lshlrev_b32 v219, 16, v219
v_add_f32 v18, v18, v219
v_cvt_pk_bf16_f32 v18, v18, v18
buffer_store_short v18, v187, s[20:23], 0 offen offset:0
v_add_f32 v97, 0x358637bd, v97
v_rcp_f32 v97, v97
s_nop 0
v_fma_f32 v18, v96, v97, v156
v_max_f32 v18, 0, v18
v_lshlrev_b32 v220, 16, v220
v_add_f32 v18, v18, v220
v_cvt_pk_bf16_f32 v18, v18, v18
buffer_store_short v18, v172, s[20:23], 0 offen offset:64
v_add_f32 v99, 0x358637bd, v99
v_rcp_f32 v99, v99
s_nop 0
v_fma_f32 v18, v98, v99, v157
v_max_f32 v18, 0, v18
v_lshlrev_b32 v221, 16, v221
v_add_f32 v18, v18, v221
v_cvt_pk_bf16_f32 v18, v18, v18
buffer_store_short v18, v173, s[20:23], 0 offen offset:64
v_add_f32 v101, 0x358637bd, v101
v_rcp_f32 v101, v101
s_nop 0
v_fma_f32 v18, v100, v101, v158
v_max_f32 v18, 0, v18
v_lshlrev_b32 v222, 16, v222
v_add_f32 v18, v18, v222
v_cvt_pk_bf16_f32 v18, v18, v18
buffer_store_short v18, v174, s[20:23], 0 offen offset:64
v_add_f32 v103, 0x358637bd, v103
v_rcp_f32 v103, v103
s_nop 0
v_fma_f32 v18, v102, v103, v159
v_max_f32 v18, 0, v18
v_lshlrev_b32 v223, 16, v223
v_add_f32 v18, v18, v223
v_cvt_pk_bf16_f32 v18, v18, v18
buffer_store_short v18, v175, s[20:23], 0 offen offset:64
v_add_f32 v105, 0x358637bd, v105
v_rcp_f32 v105, v105
s_nop 0
v_fma_f32 v18, v104, v105, v160
v_max_f32 v18, 0, v18
v_lshlrev_b32 v224, 16, v224
v_add_f32 v18, v18, v224
v_cvt_pk_bf16_f32 v18, v18, v18
buffer_store_short v18, v176, s[20:23], 0 offen offset:64
v_add_f32 v107, 0x358637bd, v107
v_rcp_f32 v107, v107
s_nop 0
v_fma_f32 v18, v106, v107, v161
v_max_f32 v18, 0, v18
v_lshlrev_b32 v225, 16, v225
v_add_f32 v18, v18, v225
v_cvt_pk_bf16_f32 v18, v18, v18
buffer_store_short v18, v177, s[20:23], 0 offen offset:64
v_add_f32 v109, 0x358637bd, v109
v_rcp_f32 v109, v109
s_nop 0
v_fma_f32 v18, v108, v109, v162
v_max_f32 v18, 0, v18
v_lshlrev_b32 v226, 16, v226
v_add_f32 v18, v18, v226
v_cvt_pk_bf16_f32 v18, v18, v18
buffer_store_short v18, v178, s[20:23], 0 offen offset:64
v_add_f32 v111, 0x358637bd, v111
v_rcp_f32 v111, v111
s_nop 0
v_fma_f32 v18, v110, v111, v163
v_max_f32 v18, 0, v18
v_lshlrev_b32 v227, 16, v227
v_add_f32 v18, v18, v227
v_cvt_pk_bf16_f32 v18, v18, v18
buffer_store_short v18, v179, s[20:23], 0 offen offset:64
v_add_f32 v113, 0x358637bd, v113
v_rcp_f32 v113, v113
s_nop 0
v_fma_f32 v18, v112, v113, v164
v_max_f32 v18, 0, v18
v_lshlrev_b32 v228, 16, v228
v_add_f32 v18, v18, v228
v_cvt_pk_bf16_f32 v18, v18, v18
buffer_store_short v18, v180, s[20:23], 0 offen offset:64
v_add_f32 v115, 0x358637bd, v115
v_rcp_f32 v115, v115
s_nop 0
v_fma_f32 v18, v114, v115, v165
v_max_f32 v18, 0, v18
v_lshlrev_b32 v229, 16, v229
v_add_f32 v18, v18, v229
v_cvt_pk_bf16_f32 v18, v18, v18
buffer_store_short v18, v181, s[20:23], 0 offen offset:64
v_add_f32 v117, 0x358637bd, v117
v_rcp_f32 v117, v117
s_nop 0
v_fma_f32 v18, v116, v117, v166
v_max_f32 v18, 0, v18
v_lshlrev_b32 v230, 16, v230
v_add_f32 v18, v18, v230
v_cvt_pk_bf16_f32 v18, v18, v18
buffer_store_short v18, v182, s[20:23], 0 offen offset:64
v_add_f32 v119, 0x358637bd, v119
v_rcp_f32 v119, v119
s_nop 0
v_fma_f32 v18, v118, v119, v167
v_max_f32 v18, 0, v18
v_lshlrev_b32 v231, 16, v231
v_add_f32 v18, v18, v231
v_cvt_pk_bf16_f32 v18, v18, v18
buffer_store_short v18, v183, s[20:23], 0 offen offset:64
v_add_f32 v121, 0x358637bd, v121
v_rcp_f32 v121, v121
s_nop 0
v_fma_f32 v18, v120, v121, v168
v_max_f32 v18, 0, v18
v_lshlrev_b32 v232, 16, v232
v_add_f32 v18, v18, v232
v_cvt_pk_bf16_f32 v18, v18, v18
buffer_store_short v18, v184, s[20:23], 0 offen offset:64
v_add_f32 v123, 0x358637bd, v123
v_rcp_f32 v123, v123
s_nop 0
v_fma_f32 v18, v122, v123, v169
v_max_f32 v18, 0, v18
v_lshlrev_b32 v233, 16, v233
v_add_f32 v18, v18, v233
v_cvt_pk_bf16_f32 v18, v18, v18
buffer_store_short v18, v185, s[20:23], 0 offen offset:64
v_add_f32 v125, 0x358637bd, v125
v_rcp_f32 v125, v125
s_nop 0
v_fma_f32 v18, v124, v125, v170
v_max_f32 v18, 0, v18
v_lshlrev_b32 v234, 16, v234
v_add_f32 v18, v18, v234
v_cvt_pk_bf16_f32 v18, v18, v18
buffer_store_short v18, v186, s[20:23], 0 offen offset:64
v_add_f32 v127, 0x358637bd, v127
v_rcp_f32 v127, v127
s_nop 0
v_fma_f32 v18, v126, v127, v171
v_max_f32 v18, 0, v18
v_lshlrev_b32 v235, 16, v235
v_add_f32 v18, v18, v235
v_cvt_pk_bf16_f32 v18, v18, v18
buffer_store_short v18, v187, s[20:23], 0 offen offset:64
M_END:
s_endpgm
.section .rodata,"a"
.p2align 6
.amdhsa_kernel main_kernel
  .amdhsa_next_free_vgpr 256
  .amdhsa_next_free_sgpr 102
  .amdhsa_accum_offset 256
  .amdhsa_group_segment_fixed_size 0
  .amdhsa_kernarg_size 96
  .amdhsa_user_sgpr_count 2
  .amdhsa_user_sgpr_kernarg_segment_ptr 1
  .amdhsa_system_sgpr_workgroup_id_x 1
.end_amdhsa_kernel
.text
```
